```python
import torch

def _softmax(x, axis=-1):
    return torch.softmax(x, dim=axis)
def _gelu(x):
    return torch.nn.functional.gelu(x, approximate="tanh")
def _silu(x):
    return torch.nn.functional.silu(x)
def _sigmoid(x):
    return torch.sigmoid(x)
def _layernorm(x, axis=-1, eps=1e-5):
    m = x.mean(dim=axis, keepdim=True)
    v = x.var(dim=axis, keepdim=True, unbiased=False)
    return (x - m) / torch.sqrt(v + eps)
def _scatter_add(tgt, idx, src, axis=0):
    return tgt.clone().index_add_(axis, idx, src)
def _segment_sum(src, seg, n):
    out = torch.zeros((n,) + src.shape[1:], dtype=src.dtype)
    return out.index_add_(0, seg, src)
def _pad(x, pw):
    flat = tuple(v for pair in reversed(pw) for v in pair)
    return torch.nn.functional.pad(x, flat)

kernel_name = 'sequential_preLN__sliding_block_cached__glu_gated_swiglu__decode'

def setup_inputs():

    _w = (lambda a: (lambda t: t.to(torch.bfloat16) if t.is_floating_point() else t)(torch.as_tensor(a)))
    def _A_setup():
        B, Sq, D = 4, 1, 640
        Hq, Hkv, Sk, Dh = 32, 32, 8192, 128
        assert Hq % Hkv == 0, (Hq, Hkv)
        return {
            "x": _w((lambda *s: torch.randn(*s, dtype=torch.bfloat16) * 0.05)(B, Sq, D)),
            "k_cache": _w((lambda *s: torch.randn(*s, dtype=torch.bfloat16) * 1.6)(B, Hkv, Sk, Dh)),
            "v_cache": _w((lambda *s: torch.randn(*s, dtype=torch.bfloat16) * 0.8)(B, Hkv, Sk, Dh)),
            "wq": _w((lambda *s: torch.randn(*s, dtype=torch.bfloat16) * 1.6)(D, Hq * Dh) * (D ** -0.5)),
            "wo": _w((lambda *s: torch.randn(*s, dtype=torch.bfloat16) * 0.8)(Hq * Dh, D) * ((Hq * Dh) ** -0.5)),
        }
    _A_in = _A_setup()

    def _B_setup():
        B, S, D, F = 4, 1, 640, 1728
        return {
            "x": _w((lambda *s: torch.randn(*s, dtype=torch.bfloat16) * 0.05)(B, S, D)),
            "w1": _w((lambda *s: torch.randn(*s, dtype=torch.bfloat16) * 0.4)(D, F) * (2.0 / D) ** 0.5),
            "w3": _w((lambda *s: torch.randn(*s, dtype=torch.bfloat16) * 0.4)(D, F) * (2.0 / D) ** 0.5),
            "w2": _w((lambda *s: torch.randn(*s, dtype=torch.bfloat16) * 0.4)(F, D) * (2.0 / F) ** 0.5),
        }
    _B_in = _B_setup()

    return {
        "A_x": _A_in["x"],
        "A_k_cache": _A_in["k_cache"],
        "A_v_cache": _A_in["v_cache"],
        "A_wq": _A_in["wq"],
        "A_wo": _A_in["wo"],
        "B_x": _B_in["x"],
        "B_w1": _B_in["w1"],
        "B_w3": _B_in["w3"],
        "B_w2": _B_in["w2"],
    }

def reference(A_x, A_k_cache, A_v_cache, A_wq, A_wo, B_x, B_w1, B_w3, B_w2):
    def _A_ref(x, k_cache, v_cache, wq, wo):
        B, Sq, D = x.shape
        Hq, Dh = 32, 128
        Hkv, Sk = k_cache.shape[1], k_cache.shape[2]
        W = min(4096, max(256, Sk // 4))
        rep = Hq // Hkv
        q = (lambda x, *d: x.permute(*d))((x @ wq).reshape(B, Sq, Hq, Dh), 0, 2, 1, 3)
        k = (lambda x, n, axis: torch.repeat_interleave(x, n, dim=axis))(k_cache[:, :, Sk - W:, :], rep, axis=1)
        v = (lambda x, n, axis: torch.repeat_interleave(x, n, dim=axis))(v_cache[:, :, Sk - W:, :], rep, axis=1)
        scores = torch.einsum("bhqd,bhkd->bhqk", q, k) * (Dh ** -0.5)
        p = _softmax(scores, axis=-1)
        o = torch.einsum("bhqk,bhkd->bhqd", p, v)
        return (lambda x, *d: x.permute(*d))(o, 0, 2, 1, 3).reshape(B, Sq, Hq * Dh) @ wo

    def _B_ref(x, w1, w3, w2):
        gate = torch.einsum("bsd,df->bsf", x, w1)
        up = torch.einsum("bsd,df->bsf", x, w3)
        h = _silu(gate) * up
        out = torch.einsum("bsf,fd->bsd", h, w2)
        return out

    x = A_x
    h = x + _A_ref(_layernorm(x, axis=-1), A_k_cache, A_v_cache, A_wq, A_wo)
    h2 = h + _B_ref(_layernorm(h, axis=-1), B_w1, B_w3, B_w2)
    return h2
```

```asm
; @launch grid=(256,1,1) block=(1024,1,1) lds=54016
.amdgcn_target "amdgcn-amd-amdhsa--gfx950"
.text
.globl sequential_preLN__sliding_block_cached__glu_gated_swiglu__decode_kernel
.p2align 12
.p2align 8
.type sequential_preLN__sliding_block_cached__glu_gated_swiglu__decode_kernel,@function
sequential_preLN__sliding_block_cached__glu_gated_swiglu__decode_kernel:
  s_cmp_ge_u32 s2, 256
  s_cbranch_scc1 L_end
  s_load_dwordx16 s[4:19], s[0:1], 0
  s_load_dwordx8 s[20:27], s[0:1], 64
  s_mov_b32 s3, s2
  s_setprio 2
  v_lshrrev_b32 v2, 6, v0
  v_and_b32 v3, 63, v0
  v_readfirstlane_b32 s60, v2
  v_lshlrev_b32 v4, 4, v3
  v_lshl_add_u32 v1, v2, 14, v4
  v_mov_b32 v8, -1
  v_mov_b32 v9, 0
  v_mov_b32 v10, 0
  v_mov_b32 v11, 0
  ds_write_b128 v9, v[8:11] offset:512
  v_mov_b32 v12, 0
  v_mov_b32 v13, 0
  v_mov_b32 v14, 0
  v_mov_b32 v15, 0
  ds_write_b128 v9, v[12:15] offset:528
  ds_write_b64 v9, v[14:15] offset:544
  ds_write_b64 v9, v[14:15] offset:552
  s_and_b32 s61, s2, 31
  s_lshr_b32 s62, s2, 6
  s_bfe_u32 s63, s2, 0x10005
  s_lshl_b32 s64, s62, 26
  s_lshl_b32 s65, s61, 21
  s_add_u32 s64, s64, s65
  s_lshl_b32 s65, s63, 18
  s_add_u32 s64, s64, s65
  s_add_u32 s64, s64, 0x180000
  s_mul_i32 s73, s3, 37
  s_lshr_b32 s73, s73, 3
  s_and_b32 s74, s73, 12
  s_lshl_b32 s74, s74, 10
  s_xor_b32 s36, s74, 0
  s_xor_b32 s37, s74, 4096
  s_xor_b32 s38, s74, 8192
  s_xor_b32 s39, s74, 12288
  s_and_b32 s73, s73, 3
  s_lshl_b32 s78, s73, 10
  s_lshl_b32 s71, s2, 7
  s_add_u32 s71, s71, 131072
  s_lshl_b32 s72, s2, 9
  s_mov_b32 s66, 0x05040100
  s_mov_b32 s67, 0x07060302
  s_mov_b32 s75, 0
  s_cmp_lg_u32 s60, 15
  s_cbranch_scc1 L_main
  s_setprio 3
  v_bfe_u32 v2, v0, 2, 2
  v_add_u32 v2, s62, v2
  v_and_b32 v2, 3, v2
  v_mul_u32_u24 v2, 320, v2
  v_and_b32 v7, 3, v0
  v_mul_u32_u24 v12, 1280, v7
  v_bfe_u32 v13, v0, 4, 2
  v_lshl_add_u32 v2, v13, 4, v2
  v_add_u32 v2, v2, v12
  v_and_b32 v12, 3, v0
  v_bfe_u32 v14, v0, 2, 2
  v_lshlrev_b32 v12, 5, v12
  v_lshl_add_u32 v12, v14, 3, v12
  v_lshl_add_u32 v12, v13, 16, v12
  s_mul_i32 s73, s62, 1310720
  s_lshl_b32 s74, s61, 8
  s_add_u32 s73, s73, s74
  s_lshl_b32 s74, s63, 7
  s_add_u32 s73, s73, s74
  s_sub_u32 s74, 0x500000, s73
  s_movk_i32 s69, 0x2000
  s_waitcnt lgkmcnt(0)
  s_mov_b32 s40, s4
  s_mov_b32 s41, s5
  s_mov_b32 s42, 5120
  s_mov_b32 s43, 0x20000
  buffer_load_dwordx4 v[28:31], v2, s[40:43], 0 offen offset:0
  buffer_load_dwordx4 v[32:35], v2, s[40:43], 0 offen offset:64
  buffer_load_dwordx4 v[36:39], v2, s[40:43], 0 offen offset:128
  buffer_load_dwordx4 v[40:43], v2, s[40:43], 0 offen offset:192
  buffer_load_dwordx4 v[44:47], v2, s[40:43], 0 offen offset:256
  s_add_u32 s48, s10, s73
  s_addc_u32 s49, s11, 0
  s_mov_b32 s50, s74
  s_mov_b32 s51, 0x20000
  s_mov_b32 s73, 0
  buffer_load_dwordx2 v[48:49], v12, s[48:51], s73 offen nt
  s_add_u32 s73, s73, s69
  buffer_load_dwordx2 v[50:51], v12, s[48:51], s73 offen nt
  s_add_u32 s73, s73, s69
  buffer_load_dwordx2 v[52:53], v12, s[48:51], s73 offen nt
  s_add_u32 s73, s73, s69
  buffer_load_dwordx2 v[54:55], v12, s[48:51], s73 offen nt
  s_add_u32 s73, s73, s69
  buffer_load_dwordx2 v[56:57], v12, s[48:51], s73 offen nt
  s_add_u32 s73, s73, s69
  buffer_load_dwordx2 v[58:59], v12, s[48:51], s73 offen nt
  s_add_u32 s73, s73, s69
  buffer_load_dwordx2 v[60:61], v12, s[48:51], s73 offen nt
  s_add_u32 s73, s73, s69
  buffer_load_dwordx2 v[62:63], v12, s[48:51], s73 offen nt
  s_add_u32 s73, s73, 204800
  buffer_load_dwordx2 v[64:65], v12, s[48:51], s73 offen nt
  s_add_u32 s73, s73, s69
  buffer_load_dwordx2 v[66:67], v12, s[48:51], s73 offen nt
  s_add_u32 s73, s73, s69
  buffer_load_dwordx2 v[68:69], v12, s[48:51], s73 offen nt
  s_add_u32 s73, s73, s69
  buffer_load_dwordx2 v[70:71], v12, s[48:51], s73 offen nt
  s_add_u32 s73, s73, s69
  buffer_load_dwordx2 v[72:73], v12, s[48:51], s73 offen nt
  s_add_u32 s73, s73, s69
  buffer_load_dwordx2 v[74:75], v12, s[48:51], s73 offen nt
  s_add_u32 s73, s73, s69
  buffer_load_dwordx2 v[76:77], v12, s[48:51], s73 offen nt
  s_add_u32 s73, s73, s69
  buffer_load_dwordx2 v[78:79], v12, s[48:51], s73 offen nt
  s_add_u32 s73, s73, 204800
  buffer_load_dwordx2 v[80:81], v12, s[48:51], s73 offen nt
  s_add_u32 s73, s73, s69
  buffer_load_dwordx2 v[82:83], v12, s[48:51], s73 offen nt
  s_add_u32 s73, s73, s69
  buffer_load_dwordx2 v[84:85], v12, s[48:51], s73 offen nt
  s_add_u32 s73, s73, s69
  buffer_load_dwordx2 v[86:87], v12, s[48:51], s73 offen nt
  s_add_u32 s73, s73, s69
  buffer_load_dwordx2 v[88:89], v12, s[48:51], s73 offen nt
  s_add_u32 s73, s73, s69
  buffer_load_dwordx2 v[90:91], v12, s[48:51], s73 offen nt
  s_add_u32 s73, s73, s69
  buffer_load_dwordx2 v[92:93], v12, s[48:51], s73 offen nt
  s_add_u32 s73, s73, s69
  buffer_load_dwordx2 v[94:95], v12, s[48:51], s73 offen nt
  s_add_u32 s73, s73, 204800
  buffer_load_dwordx2 v[96:97], v12, s[48:51], s73 offen nt
  s_add_u32 s73, s73, s69
  buffer_load_dwordx2 v[98:99], v12, s[48:51], s73 offen nt
  s_add_u32 s73, s73, s69
  buffer_load_dwordx2 v[100:101], v12, s[48:51], s73 offen nt
  s_add_u32 s73, s73, s69
  buffer_load_dwordx2 v[102:103], v12, s[48:51], s73 offen nt
  s_add_u32 s73, s73, s69
  buffer_load_dwordx2 v[104:105], v12, s[48:51], s73 offen nt
  s_add_u32 s73, s73, s69
  buffer_load_dwordx2 v[106:107], v12, s[48:51], s73 offen nt
  s_add_u32 s73, s73, s69
  buffer_load_dwordx2 v[108:109], v12, s[48:51], s73 offen nt
  s_add_u32 s73, s73, s69
  buffer_load_dwordx2 v[110:111], v12, s[48:51], s73 offen nt
  s_add_u32 s73, s73, 204800
  buffer_load_dwordx2 v[112:113], v12, s[48:51], s73 offen nt
  s_add_u32 s73, s73, s69
  buffer_load_dwordx2 v[114:115], v12, s[48:51], s73 offen nt
  s_add_u32 s73, s73, s69
  buffer_load_dwordx2 v[116:117], v12, s[48:51], s73 offen nt
  s_add_u32 s73, s73, s69
  buffer_load_dwordx2 v[118:119], v12, s[48:51], s73 offen nt
  s_add_u32 s73, s73, s69
  buffer_load_dwordx2 v[120:121], v12, s[48:51], s73 offen nt
  s_add_u32 s73, s73, s69
  buffer_load_dwordx2 v[122:123], v12, s[48:51], s73 offen nt
  s_add_u32 s73, s73, s69
  buffer_load_dwordx2 v[124:125], v12, s[48:51], s73 offen nt
  s_add_u32 s73, s73, s69
  buffer_load_dwordx2 v[126:127], v12, s[48:51], s73 offen nt
  s_barrier
  s_setprio 1
  s_add_u32 s28, s6, s64
  s_addc_u32 s29, s7, 0
  s_mov_b32 s30, 262144
  s_mov_b32 s31, 0x20000
  s_add_u32 s32, s8, s64
  s_addc_u32 s33, s9, 0
  s_mov_b32 s34, 262144
  s_mov_b32 s35, 0x20000
  s_mov_b32 s44, s26
  s_mov_b32 s45, s27
  s_mov_b32 s46, 731136
  s_mov_b32 s47, 0x20000
  s_waitcnt vmcnt(40)
  v_lshlrev_b32 v8, 16, v28
  v_and_b32 v9, 0xffff0000, v28
  v_lshlrev_b32 v10, 16, v29
  v_and_b32 v11, 0xffff0000, v29
  v_lshlrev_b32 v12, 16, v30
  v_and_b32 v13, 0xffff0000, v30
  v_lshlrev_b32 v14, 16, v31
  v_and_b32 v15, 0xffff0000, v31
  v_lshlrev_b32 v16, 16, v32
  v_and_b32 v17, 0xffff0000, v32
  v_lshlrev_b32 v18, 16, v33
  v_and_b32 v19, 0xffff0000, v33
  v_lshlrev_b32 v20, 16, v34
  v_and_b32 v21, 0xffff0000, v34
  v_lshlrev_b32 v22, 16, v35
  v_and_b32 v23, 0xffff0000, v35
  v_lshlrev_b32 v24, 16, v36
  v_and_b32 v25, 0xffff0000, v36
  v_lshlrev_b32 v26, 16, v37
  v_and_b32 v27, 0xffff0000, v37
  v_lshlrev_b32 v28, 16, v38
  v_and_b32 v29, 0xffff0000, v38
  v_lshlrev_b32 v30, 16, v39
  v_and_b32 v31, 0xffff0000, v39
  v_lshlrev_b32 v32, 16, v40
  v_and_b32 v33, 0xffff0000, v40
  v_lshlrev_b32 v34, 16, v41
  v_and_b32 v35, 0xffff0000, v41
  v_lshlrev_b32 v36, 16, v42
  v_and_b32 v37, 0xffff0000, v42
  v_lshlrev_b32 v38, 16, v43
  v_and_b32 v39, 0xffff0000, v43
  v_lshlrev_b32 v40, 16, v44
  v_and_b32 v41, 0xffff0000, v44
  v_lshlrev_b32 v42, 16, v45
  v_and_b32 v43, 0xffff0000, v45
  v_lshlrev_b32 v44, 16, v46
  v_and_b32 v45, 0xffff0000, v46
  v_lshlrev_b32 v46, 16, v47
  v_and_b32 v47, 0xffff0000, v47
  v_pk_add_f32 v[2:3], v[8:9], v[10:11]
  v_pk_add_f32 v[4:5], v[12:13], v[14:15]
  v_pk_add_f32 v[2:3], v[2:3], v[16:17]
  v_pk_add_f32 v[4:5], v[4:5], v[18:19]
  v_pk_add_f32 v[2:3], v[2:3], v[20:21]
  v_pk_add_f32 v[4:5], v[4:5], v[22:23]
  v_pk_add_f32 v[2:3], v[2:3], v[24:25]
  v_pk_add_f32 v[4:5], v[4:5], v[26:27]
  v_pk_add_f32 v[2:3], v[2:3], v[28:29]
  v_pk_add_f32 v[4:5], v[4:5], v[30:31]
  v_pk_add_f32 v[2:3], v[2:3], v[32:33]
  v_pk_add_f32 v[4:5], v[4:5], v[34:35]
  v_pk_add_f32 v[2:3], v[2:3], v[36:37]
  v_pk_add_f32 v[4:5], v[4:5], v[38:39]
  v_pk_add_f32 v[2:3], v[2:3], v[40:41]
  v_pk_add_f32 v[4:5], v[4:5], v[42:43]
  v_pk_add_f32 v[2:3], v[2:3], v[44:45]
  v_pk_add_f32 v[4:5], v[4:5], v[46:47]
  v_pk_add_f32 v[2:3], v[2:3], v[4:5]
  v_add_f32 v2, v2, v3
  s_nop 1
  v_add_f32_dpp v2, v2, v2 row_ror:4 row_mask:0xf bank_mask:0xf
  s_nop 1
  v_add_f32_dpp v2, v2, v2 row_ror:8 row_mask:0xf bank_mask:0xf
  v_mov_b32 v3, v2
  s_nop 1
  v_permlane16_swap_b32 v2, v3
  v_add_f32 v2, v2, v3
  v_mov_b32 v3, v2
  s_nop 1
  v_permlane32_swap_b32 v2, v3
  v_add_f32 v2, v2, v3
  v_mul_f32 v2, 0xbacccccd, v2
  v_mov_b32 v3, v2
  v_mov_b32 v4, 0
  v_mov_b32 v5, 0
  v_pk_add_f32 v[6:7], v[8:9], v[2:3]
  v_pk_fma_f32 v[4:5], v[6:7], v[6:7], v[4:5]
  v_pk_add_f32 v[6:7], v[10:11], v[2:3]
  v_pk_fma_f32 v[4:5], v[6:7], v[6:7], v[4:5]
  v_pk_add_f32 v[6:7], v[12:13], v[2:3]
  v_pk_fma_f32 v[4:5], v[6:7], v[6:7], v[4:5]
  v_pk_add_f32 v[6:7], v[14:15], v[2:3]
  v_pk_fma_f32 v[4:5], v[6:7], v[6:7], v[4:5]
  v_pk_add_f32 v[6:7], v[16:17], v[2:3]
  v_pk_fma_f32 v[4:5], v[6:7], v[6:7], v[4:5]
  v_pk_add_f32 v[6:7], v[18:19], v[2:3]
  v_pk_fma_f32 v[4:5], v[6:7], v[6:7], v[4:5]
  v_pk_add_f32 v[6:7], v[20:21], v[2:3]
  v_pk_fma_f32 v[4:5], v[6:7], v[6:7], v[4:5]
  v_pk_add_f32 v[6:7], v[22:23], v[2:3]
  v_pk_fma_f32 v[4:5], v[6:7], v[6:7], v[4:5]
  v_pk_add_f32 v[6:7], v[24:25], v[2:3]
  v_pk_fma_f32 v[4:5], v[6:7], v[6:7], v[4:5]
  v_pk_add_f32 v[6:7], v[26:27], v[2:3]
  v_pk_fma_f32 v[4:5], v[6:7], v[6:7], v[4:5]
  v_pk_add_f32 v[6:7], v[28:29], v[2:3]
  v_pk_fma_f32 v[4:5], v[6:7], v[6:7], v[4:5]
  v_pk_add_f32 v[6:7], v[30:31], v[2:3]
  v_pk_fma_f32 v[4:5], v[6:7], v[6:7], v[4:5]
  v_pk_add_f32 v[6:7], v[32:33], v[2:3]
  v_pk_fma_f32 v[4:5], v[6:7], v[6:7], v[4:5]
  v_pk_add_f32 v[6:7], v[34:35], v[2:3]
  v_pk_fma_f32 v[4:5], v[6:7], v[6:7], v[4:5]
  v_pk_add_f32 v[6:7], v[36:37], v[2:3]
  v_pk_fma_f32 v[4:5], v[6:7], v[6:7], v[4:5]
  v_pk_add_f32 v[6:7], v[38:39], v[2:3]
  v_pk_fma_f32 v[4:5], v[6:7], v[6:7], v[4:5]
  v_pk_add_f32 v[6:7], v[40:41], v[2:3]
  v_pk_fma_f32 v[4:5], v[6:7], v[6:7], v[4:5]
  v_pk_add_f32 v[6:7], v[42:43], v[2:3]
  v_pk_fma_f32 v[4:5], v[6:7], v[6:7], v[4:5]
  v_pk_add_f32 v[6:7], v[44:45], v[2:3]
  v_pk_fma_f32 v[4:5], v[6:7], v[6:7], v[4:5]
  v_pk_add_f32 v[6:7], v[46:47], v[2:3]
  v_pk_fma_f32 v[4:5], v[6:7], v[6:7], v[4:5]
  v_add_f32 v4, v4, v5
  s_nop 1
  v_add_f32_dpp v4, v4, v4 row_ror:4 row_mask:0xf bank_mask:0xf
  s_nop 1
  v_add_f32_dpp v4, v4, v4 row_ror:8 row_mask:0xf bank_mask:0xf
  v_mov_b32 v5, v4
  s_nop 1
  v_permlane16_swap_b32 v4, v5
  v_add_f32 v4, v4, v5
  v_mov_b32 v5, v4
  s_nop 1
  v_permlane32_swap_b32 v4, v5
  v_add_f32 v4, v4, v5
  v_mul_f32 v4, 0x3acccccd, v4
  v_cvt_pk_bf16_f32 v4, 0, v4
  v_add_f32 v4, 0x3727c5ac, v4
  v_cvt_pk_bf16_f32 v4, 0, v4
  v_sqrt_f32 v4, v4
  v_cvt_pk_bf16_f32 v2, 0, v2
  v_mov_b32 v3, v2
  v_cvt_pk_bf16_f32 v4, 0, v4
  v_rcp_f32 v4, v4
  v_pk_add_f32 v[8:9], v[8:9], v[2:3]
  v_pk_add_f32 v[10:11], v[10:11], v[2:3]
  v_pk_add_f32 v[12:13], v[12:13], v[2:3]
  v_pk_add_f32 v[14:15], v[14:15], v[2:3]
  v_pk_add_f32 v[16:17], v[16:17], v[2:3]
  v_pk_add_f32 v[18:19], v[18:19], v[2:3]
  v_pk_add_f32 v[20:21], v[20:21], v[2:3]
  v_pk_add_f32 v[22:23], v[22:23], v[2:3]
  v_pk_add_f32 v[24:25], v[24:25], v[2:3]
  v_pk_add_f32 v[26:27], v[26:27], v[2:3]
  v_pk_add_f32 v[28:29], v[28:29], v[2:3]
  v_pk_add_f32 v[30:31], v[30:31], v[2:3]
  v_pk_add_f32 v[32:33], v[32:33], v[2:3]
  v_pk_add_f32 v[34:35], v[34:35], v[2:3]
  v_pk_add_f32 v[36:37], v[36:37], v[2:3]
  v_pk_add_f32 v[38:39], v[38:39], v[2:3]
  v_pk_add_f32 v[40:41], v[40:41], v[2:3]
  v_pk_add_f32 v[42:43], v[42:43], v[2:3]
  v_pk_add_f32 v[44:45], v[44:45], v[2:3]
  v_pk_add_f32 v[46:47], v[46:47], v[2:3]
  v_mov_b32 v5, v4
  v_cvt_pk_bf16_f32 v8, 0, v8
  v_cvt_pk_bf16_f32 v9, 0, v9
  v_cvt_pk_bf16_f32 v10, 0, v10
  v_cvt_pk_bf16_f32 v11, 0, v11
  v_cvt_pk_bf16_f32 v12, 0, v12
  v_cvt_pk_bf16_f32 v13, 0, v13
  v_cvt_pk_bf16_f32 v14, 0, v14
  v_cvt_pk_bf16_f32 v15, 0, v15
  v_cvt_pk_bf16_f32 v16, 0, v16
  v_cvt_pk_bf16_f32 v17, 0, v17
  v_cvt_pk_bf16_f32 v18, 0, v18
  v_cvt_pk_bf16_f32 v19, 0, v19
  v_cvt_pk_bf16_f32 v20, 0, v20
  v_cvt_pk_bf16_f32 v21, 0, v21
  v_cvt_pk_bf16_f32 v22, 0, v22
  v_cvt_pk_bf16_f32 v23, 0, v23
  v_cvt_pk_bf16_f32 v24, 0, v24
  v_cvt_pk_bf16_f32 v25, 0, v25
  v_cvt_pk_bf16_f32 v26, 0, v26
  v_cvt_pk_bf16_f32 v27, 0, v27
  v_cvt_pk_bf16_f32 v28, 0, v28
  v_cvt_pk_bf16_f32 v29, 0, v29
  v_cvt_pk_bf16_f32 v30, 0, v30
  v_cvt_pk_bf16_f32 v31, 0, v31
  v_cvt_pk_bf16_f32 v32, 0, v32
  v_cvt_pk_bf16_f32 v33, 0, v33
  v_cvt_pk_bf16_f32 v34, 0, v34
  v_cvt_pk_bf16_f32 v35, 0, v35
  v_cvt_pk_bf16_f32 v36, 0, v36
  v_cvt_pk_bf16_f32 v37, 0, v37
  v_cvt_pk_bf16_f32 v38, 0, v38
  v_cvt_pk_bf16_f32 v39, 0, v39
  v_cvt_pk_bf16_f32 v40, 0, v40
  v_cvt_pk_bf16_f32 v41, 0, v41
  v_cvt_pk_bf16_f32 v42, 0, v42
  v_cvt_pk_bf16_f32 v43, 0, v43
  v_cvt_pk_bf16_f32 v44, 0, v44
  v_cvt_pk_bf16_f32 v45, 0, v45
  v_cvt_pk_bf16_f32 v46, 0, v46
  v_cvt_pk_bf16_f32 v47, 0, v47
  v_pk_mul_f32 v[8:9], v[8:9], v[4:5]
  v_pk_mul_f32 v[10:11], v[10:11], v[4:5]
  v_pk_mul_f32 v[12:13], v[12:13], v[4:5]
  v_pk_mul_f32 v[14:15], v[14:15], v[4:5]
  v_pk_mul_f32 v[16:17], v[16:17], v[4:5]
  v_pk_mul_f32 v[18:19], v[18:19], v[4:5]
  v_pk_mul_f32 v[20:21], v[20:21], v[4:5]
  v_pk_mul_f32 v[22:23], v[22:23], v[4:5]
  v_pk_mul_f32 v[24:25], v[24:25], v[4:5]
  v_pk_mul_f32 v[26:27], v[26:27], v[4:5]
  v_pk_mul_f32 v[28:29], v[28:29], v[4:5]
  v_pk_mul_f32 v[30:31], v[30:31], v[4:5]
  v_pk_mul_f32 v[32:33], v[32:33], v[4:5]
  v_pk_mul_f32 v[34:35], v[34:35], v[4:5]
  v_pk_mul_f32 v[36:37], v[36:37], v[4:5]
  v_pk_mul_f32 v[38:39], v[38:39], v[4:5]
  v_pk_mul_f32 v[40:41], v[40:41], v[4:5]
  v_pk_mul_f32 v[42:43], v[42:43], v[4:5]
  v_pk_mul_f32 v[44:45], v[44:45], v[4:5]
  v_pk_mul_f32 v[46:47], v[46:47], v[4:5]
  v_cvt_pk_bf16_f32 v8, v8, v9
  v_cvt_pk_bf16_f32 v9, v10, v11
  v_cvt_pk_bf16_f32 v10, v12, v13
  v_cvt_pk_bf16_f32 v11, v14, v15
  v_cvt_pk_bf16_f32 v12, v16, v17
  v_cvt_pk_bf16_f32 v13, v18, v19
  v_cvt_pk_bf16_f32 v14, v20, v21
  v_cvt_pk_bf16_f32 v15, v22, v23
  v_cvt_pk_bf16_f32 v16, v24, v25
  v_cvt_pk_bf16_f32 v17, v26, v27
  v_cvt_pk_bf16_f32 v18, v28, v29
  v_cvt_pk_bf16_f32 v19, v30, v31
  v_cvt_pk_bf16_f32 v20, v32, v33
  v_cvt_pk_bf16_f32 v21, v34, v35
  v_cvt_pk_bf16_f32 v22, v36, v37
  v_cvt_pk_bf16_f32 v23, v38, v39
  v_cvt_pk_bf16_f32 v24, v40, v41
  v_cvt_pk_bf16_f32 v25, v42, v43
  v_cvt_pk_bf16_f32 v26, v44, v45
  v_cvt_pk_bf16_f32 v27, v46, v47
  s_waitcnt vmcnt(32)
  v_perm_b32 v28, v50, v48, s66
  v_perm_b32 v29, v54, v52, s66
  v_perm_b32 v30, v58, v56, s66
  v_perm_b32 v31, v62, v60, s66
  v_perm_b32 v32, v50, v48, s67
  v_perm_b32 v33, v54, v52, s67
  v_perm_b32 v34, v58, v56, s67
  v_perm_b32 v35, v62, v60, s67
  v_perm_b32 v36, v51, v49, s66
  v_perm_b32 v37, v55, v53, s66
  v_perm_b32 v38, v59, v57, s66
  v_perm_b32 v39, v63, v61, s66
  v_perm_b32 v40, v51, v49, s67
  v_perm_b32 v41, v55, v53, s67
  v_perm_b32 v42, v59, v57, s67
  v_perm_b32 v43, v63, v61, s67
  v_mfma_f32_16x16x32_bf16 v[48:51], v[28:31], v[8:11], 0
  v_mfma_f32_16x16x32_bf16 v[52:55], v[32:35], v[8:11], 0
  v_mfma_f32_16x16x32_bf16 v[56:59], v[36:39], v[8:11], 0
  v_mfma_f32_16x16x32_bf16 v[60:63], v[40:43], v[8:11], 0
  s_waitcnt vmcnt(24)
  v_perm_b32 v28, v66, v64, s66
  v_perm_b32 v29, v70, v68, s66
  v_perm_b32 v30, v74, v72, s66
  v_perm_b32 v31, v78, v76, s66
  v_perm_b32 v32, v66, v64, s67
  v_perm_b32 v33, v70, v68, s67
  v_perm_b32 v34, v74, v72, s67
  v_perm_b32 v35, v78, v76, s67
  v_perm_b32 v36, v67, v65, s66
  v_perm_b32 v37, v71, v69, s66
  v_perm_b32 v38, v75, v73, s66
  v_perm_b32 v39, v79, v77, s66
  v_perm_b32 v40, v67, v65, s67
  v_perm_b32 v41, v71, v69, s67
  v_perm_b32 v42, v75, v73, s67
  v_perm_b32 v43, v79, v77, s67
  v_mfma_f32_16x16x32_bf16 v[48:51], v[28:31], v[12:15], v[48:51]
  v_mfma_f32_16x16x32_bf16 v[52:55], v[32:35], v[12:15], v[52:55]
  v_mfma_f32_16x16x32_bf16 v[56:59], v[36:39], v[12:15], v[56:59]
  v_mfma_f32_16x16x32_bf16 v[60:63], v[40:43], v[12:15], v[60:63]
  s_waitcnt vmcnt(16)
  v_perm_b32 v28, v82, v80, s66
  v_perm_b32 v29, v86, v84, s66
  v_perm_b32 v30, v90, v88, s66
  v_perm_b32 v31, v94, v92, s66
  v_perm_b32 v32, v82, v80, s67
  v_perm_b32 v33, v86, v84, s67
  v_perm_b32 v34, v90, v88, s67
  v_perm_b32 v35, v94, v92, s67
  v_perm_b32 v36, v83, v81, s66
  v_perm_b32 v37, v87, v85, s66
  v_perm_b32 v38, v91, v89, s66
  v_perm_b32 v39, v95, v93, s66
  v_perm_b32 v40, v83, v81, s67
  v_perm_b32 v41, v87, v85, s67
  v_perm_b32 v42, v91, v89, s67
  v_perm_b32 v43, v95, v93, s67
  v_mfma_f32_16x16x32_bf16 v[48:51], v[28:31], v[16:19], v[48:51]
  v_mfma_f32_16x16x32_bf16 v[52:55], v[32:35], v[16:19], v[52:55]
  v_mfma_f32_16x16x32_bf16 v[56:59], v[36:39], v[16:19], v[56:59]
  v_mfma_f32_16x16x32_bf16 v[60:63], v[40:43], v[16:19], v[60:63]
  s_waitcnt vmcnt(8)
  v_perm_b32 v28, v98, v96, s66
  v_perm_b32 v29, v102, v100, s66
  v_perm_b32 v30, v106, v104, s66
  v_perm_b32 v31, v110, v108, s66
  v_perm_b32 v32, v98, v96, s67
  v_perm_b32 v33, v102, v100, s67
  v_perm_b32 v34, v106, v104, s67
  v_perm_b32 v35, v110, v108, s67
  v_perm_b32 v36, v99, v97, s66
  v_perm_b32 v37, v103, v101, s66
  v_perm_b32 v38, v107, v105, s66
  v_perm_b32 v39, v111, v109, s66
  v_perm_b32 v40, v99, v97, s67
  v_perm_b32 v41, v103, v101, s67
  v_perm_b32 v42, v107, v105, s67
  v_perm_b32 v43, v111, v109, s67
  v_mfma_f32_16x16x32_bf16 v[48:51], v[28:31], v[20:23], v[48:51]
  v_mfma_f32_16x16x32_bf16 v[52:55], v[32:35], v[20:23], v[52:55]
  v_mfma_f32_16x16x32_bf16 v[56:59], v[36:39], v[20:23], v[56:59]
  v_mfma_f32_16x16x32_bf16 v[60:63], v[40:43], v[20:23], v[60:63]
  s_waitcnt vmcnt(0)
  v_perm_b32 v28, v114, v112, s66
  v_perm_b32 v29, v118, v116, s66
  v_perm_b32 v30, v122, v120, s66
  v_perm_b32 v31, v126, v124, s66
  v_perm_b32 v32, v114, v112, s67
  v_perm_b32 v33, v118, v116, s67
  v_perm_b32 v34, v122, v120, s67
  v_perm_b32 v35, v126, v124, s67
  v_perm_b32 v36, v115, v113, s66
  v_perm_b32 v37, v119, v117, s66
  v_perm_b32 v38, v123, v121, s66
  v_perm_b32 v39, v127, v125, s66
  v_perm_b32 v40, v115, v113, s67
  v_perm_b32 v41, v119, v117, s67
  v_perm_b32 v42, v123, v121, s67
  v_perm_b32 v43, v127, v125, s67
  v_mfma_f32_16x16x32_bf16 v[48:51], v[28:31], v[24:27], v[48:51]
  v_mfma_f32_16x16x32_bf16 v[52:55], v[32:35], v[24:27], v[52:55]
  v_mfma_f32_16x16x32_bf16 v[56:59], v[36:39], v[24:27], v[56:59]
  v_mfma_f32_16x16x32_bf16 v[60:63], v[40:43], v[24:27], v[60:63]
  v_and_b32 v2, 3, v0
  v_bfe_u32 v3, v0, 2, 4
  v_lshlrev_b32 v2, 8, v2
  v_lshl_add_u32 v2, v3, 4, v2
  v_mov_b32 v4, 0
  v_mov_b32 v5, 1
  s_mov_b32 s75, 1
  v_mov_b32_dpp v48, v52 row_shr:4 row_mask:0xf bank_mask:0x2
  v_mov_b32_dpp v49, v53 row_shr:4 row_mask:0xf bank_mask:0x2
  v_mov_b32_dpp v50, v54 row_shr:4 row_mask:0xf bank_mask:0x2
  v_mov_b32_dpp v51, v55 row_shr:4 row_mask:0xf bank_mask:0x2
  v_mov_b32_dpp v48, v56 row_shr:8 row_mask:0xf bank_mask:0x4
  v_mov_b32_dpp v49, v57 row_shr:8 row_mask:0xf bank_mask:0x4
  v_mov_b32_dpp v50, v58 row_shr:8 row_mask:0xf bank_mask:0x4
  v_mov_b32_dpp v51, v59 row_shr:8 row_mask:0xf bank_mask:0x4
  v_mov_b32_dpp v48, v60 row_shr:12 row_mask:0xf bank_mask:0x8
  v_mov_b32_dpp v49, v61 row_shr:12 row_mask:0xf bank_mask:0x8
  v_mov_b32_dpp v50, v62 row_shr:12 row_mask:0xf bank_mask:0x8
  v_mov_b32_dpp v51, v63 row_shr:12 row_mask:0xf bank_mask:0x8
  ds_write_b128 v2, v[48:51] offset:1024
  ds_write_b32 v4, v5 offset:532
  s_setprio 2
  s_branch L_stream
L_stats:
  v_lshlrev_b32 v14, 3, v2
  ds_read_b64 v[10:11], v14 offset:256
  v_lshlrev_b32 v14, 2, v2
  s_waitcnt lgkmcnt(0)
  v_mov_b32 v12, v10
  s_nop 1
  v_max_f32_dpp v12, v12, v12 quad_perm:[1,0,3,2] row_mask:0xf bank_mask:0xf
  s_nop 1
  v_max_f32_dpp v12, v12, v12 quad_perm:[2,3,0,1] row_mask:0xf bank_mask:0xf
  s_nop 1
  v_max_f32_dpp v12, v12, v12 row_half_mirror row_mask:0xf bank_mask:0xf
  s_nop 1
  v_max_f32_dpp v12, v12, v12 row_mirror row_mask:0xf bank_mask:0xf
  v_sub_f32 v10, v10, v12
  v_exp_f32 v10, v10
  s_nop 0
  v_mul_f32 v11, v10, v11
  s_nop 1
  v_add_f32_dpp v11, v11, v11 quad_perm:[1,0,3,2] row_mask:0xf bank_mask:0xf
  s_nop 1
  v_add_f32_dpp v11, v11, v11 quad_perm:[2,3,0,1] row_mask:0xf bank_mask:0xf
  s_nop 1
  v_add_f32_dpp v11, v11, v11 row_half_mirror row_mask:0xf bank_mask:0xf
  s_nop 1
  v_add_f32_dpp v11, v11, v11 row_mirror row_mask:0xf bank_mask:0xf
  v_rcp_f32 v13, v11
  v_log_f32 v11, v11
  v_mul_f32 v10, v10, v13
  ds_write_b32 v14, v10 offset:384
  v_add_f32 v11, v11, v12
  v_min_u32 v11, -2, v11
  ds_write_b32 v5, v11 offset:448
  s_branch L_statsdone
L_ticket:
  s_cmp_eq_u32 s76, 1
  s_cbranch_scc1 L_tk1
  s_mov_b32 s65, 200000
  s_branch Lpoll0_in
Lpoll0:
  s_sleep 4
  s_sub_u32 s65, s65, 1
  s_cbranch_scc1 Lpoll0_out
Lpoll0_in:
  ds_read_b32 v6, v5 offset:528
  s_waitcnt lgkmcnt(0)
Lpoll0_ck:
  v_cmp_ne_u32 vcc, 1, v6
  s_cbranch_vccnz Lpoll0
Lpoll0_out:
  s_atomic_add s64, s[26:27], s73 glc
  s_mov_b32 s63, 0
L_tk1:
  s_waitcnt lgkmcnt(0)
  s_mul_i32 s64, s64, 8
  s_add_u32 s64, s64, s77
  s_cmp_ge_u32 s64, 184
  s_cbranch_scc1 L_tkw
  s_mov_b32 s65, 22222
  s_branch Lpoll1_ck
Lpoll1:
  s_sleep 32
  s_sub_u32 s65, s65, 1
  s_cbranch_scc1 Lpoll1_out
Lpoll1_in:
  s_load_dword s63, s[24:25], 128 glc
  s_waitcnt lgkmcnt(0)
Lpoll1_ck:
  s_cmp_lt_u32 s63, 32
  s_cbranch_scc1 Lpoll1
Lpoll1_out:
L_tkw:
  v_mov_b32 v6, s64
  ds_write_b32 v5, v6 offset:512
  s_branch L_tkdone
.p2align 12
L_main:
  s_waitcnt lgkmcnt(0)
  s_add_u32 s28, s6, s64
  s_addc_u32 s29, s7, 0
  s_mov_b32 s30, 262144
  s_mov_b32 s31, 0x20000
  s_add_u32 s32, s8, s64
  s_addc_u32 s33, s9, 0
  s_mov_b32 s34, 262144
  s_mov_b32 s35, 0x20000
  s_mov_b32 s40, s4
  s_mov_b32 s41, s5
  s_mov_b32 s42, 5120
  s_mov_b32 s43, 0x20000
  s_mov_b32 s44, s26
  s_mov_b32 s45, s27
  s_mov_b32 s46, 731136
  s_mov_b32 s47, 0x20000
  s_mul_i32 s77, s61, 4352
  s_add_u32 s77, s77, 557056
  s_cmp_lt_u32 s60, 13
  s_cbranch_scc1 L_stream
  v_mov_b32 v5, 0
  v_mov_b32 v7, 1
  s_cmp_lg_u32 s60, 14
  s_cbranch_scc1 L_gowave
  s_mov_b32 s75, 1
  v_mov_b32 v6, 163328
  v_cmp_gt_u32 vcc, 32, v3
  s_nop 1
  v_cndmask_b32 v6, v6, 0, vcc
  v_add_u32 v6, v6, v4
  v_mov_b32 v9, -1
  v_mov_b32 v10, -1
  v_mov_b32 v11, -1
  buffer_store_dwordx4 v[8:11], v6, s[44:47], s72 offen sc1
  buffer_store_dword v8, v5, s[44:47], s71 offen sc1
  s_barrier
  s_setprio 1
  s_lshl_b32 s76, s61, 3
  s_lshl_b32 s74, s63, 2
  s_add_u32 s76, s76, s74
  s_add_u32 s76, s76, s62
  s_lshl_b32 s76, s76, 10
  s_add_u32 s76, s76, 294912
  s_mov_b32 s65, 266666
  s_branch Lpoll2_in
Lpoll2:
  s_sleep 2
  s_sub_u32 s65, s65, 1
  s_cbranch_scc1 Lpoll2_out
Lpoll2_in:
  ds_read_b32 v6, v5 offset:532
  s_waitcnt lgkmcnt(0)
Lpoll2_ck:
  v_cmp_ne_u32 vcc, 1, v6
  s_cbranch_vccnz Lpoll2
Lpoll2_out:
  ds_read_b128 v[8:11], v4 offset:1024
  s_load_dword s74, s[24:25], 0
  s_setprio 3
  s_waitcnt lgkmcnt(0)
  buffer_store_dwordx4 v[8:11], v4, s[44:47], s76 offen sc1
  s_cmp_lg_u32 s74, 0
  s_cbranch_scc1 L_gook
  s_mov_b32 s65, 100000
  s_branch Lpoll3_in
Lpoll3:
  s_sleep 4
  s_sub_u32 s65, s65, 1
  s_cbranch_scc1 Lpoll3_out
Lpoll3_in:
  global_load_dword v6, v5, s[24:25] sc1
  s_waitcnt vmcnt(0)
Lpoll3_ck:
  v_cmp_eq_u32 vcc, 0, v6
  s_cbranch_vccnz Lpoll3
Lpoll3_out:
L_gook:
  s_waitcnt vmcnt(0)
  s_mov_b32 s74, 1
  s_atomic_add s74, s[26:27], s77 glc
  ds_write_b32 v5, v7 offset:528
  s_waitcnt lgkmcnt(0)
  s_cmp_lg_u32 s74, 7
  s_cbranch_scc1 L_nolast
  s_atomic_add s75, s[24:25], 128
L_nolast:
  s_setprio 2
  s_branch L_stream
L_gowave:
  s_cmp_lg_u32 s2, 0
  s_cbranch_scc1 L_stream
  s_mov_b32 s75, 1
  v_min_u32 v6, 39, v3
  v_mul_u32_u24 v6, 4352, v6
  s_mov_b32 s73, 557056
  buffer_store_dword v5, v6, s[44:47], s73 offen sc1
  s_barrier
  s_waitcnt vmcnt(0)
  s_atomic_add s75, s[24:25], 0
  s_branch L_stream
L_qgather:
  v_mov_b32 v5, 0
  v_mov_b32 v7, 1
  v_and_b32 v6, 15, v0
  v_lshlrev_b32 v6, 4, v6
  v_bfe_u32 v12, v0, 4, 2
  v_lshl_add_u32 v12, v12, 10, v6
  s_lshl_b32 s73, s61, 13
  s_lshl_b32 s74, s62, 8
  s_add_u32 s73, s73, s74
  s_lshl_b32 s74, s60, 12
  s_add_u32 s73, s73, s74
  s_add_u32 s73, s73, 294912
  v_lshlrev_b32 v6, 1, v0
  s_cmp_eq_u32 s60, 1
  s_cbranch_scc1 L_qg1
  s_mov_b32 s65, 200000
  s_branch Lpoll4_in
Lpoll4:
  s_sleep 4
  s_sub_u32 s65, s65, 1
  s_cbranch_scc1 Lpoll4_out
Lpoll4_in:
  ds_read_b32 v8, v5 offset:528
  s_waitcnt lgkmcnt(0)
Lpoll4_ck:
  v_cmp_ne_u32 vcc, 1, v8
  s_cbranch_vccnz Lpoll4
Lpoll4_out:
  s_mov_b32 s65, 40000
  s_branch Lpoll5_in
Lpoll5:
  s_sleep 16
  s_sub_u32 s65, s65, 1
  s_cbranch_scc1 Lpoll5_out
Lpoll5_in:
  s_load_dword s74, s[26:27], s77 glc
  s_waitcnt lgkmcnt(0)
Lpoll5_ck:
  s_cmp_lg_u32 s74, 8
  s_cbranch_scc1 Lpoll5
Lpoll5_out:
  ds_write_b32 v5, v7 offset:536
  s_branch L_qg2
L_qg1:
  s_mov_b32 s65, 266666
  s_branch Lpoll6_in
Lpoll6:
  s_sleep 2
  s_sub_u32 s65, s65, 1
  s_cbranch_scc1 Lpoll6_out
Lpoll6_in:
  ds_read_b32 v8, v5 offset:536
  s_waitcnt lgkmcnt(0)
Lpoll6_ck:
  v_cmp_ne_u32 vcc, 1, v8
  s_cbranch_vccnz Lpoll6
Lpoll6_out:
L_qg2:
  s_setprio 3
  buffer_load_dwordx4 v[8:11], v12, s[44:47], s73 offen sc1
  s_setprio 1
  s_waitcnt vmcnt(0)
  v_permlane32_swap_b32 v8, v10
  v_permlane32_swap_b32 v9, v11
  v_pk_add_f32 v[8:9], v[8:9], v[10:11]
  s_nop 1
  v_permlane16_swap_b32 v8, v9
  v_add_f32 v8, v8, v9
  v_cvt_pk_bf16_f32 v8, v8, v8
  ds_write_b16 v6, v8 offset:0
  s_mov_b64 exec, 1
  ds_add_u32 v5, v7 offset:524
  s_mov_b64 exec, -1
  s_branch L_qgdone
L_stream:
  v_xor_b32 v1, s78, v1
  v_xor_b32 v2, 1024, v1
  v_xor_b32 v3, 2048, v1
  v_xor_b32 v4, 3072, v1
  buffer_load_dwordx4 v[64:67], v1, s[28:31], s36 offen nt
  buffer_load_dwordx4 v[68:71], v2, s[28:31], s36 offen nt
  s_cmp_eq_u32 s75, 1
  s_cbranch_scc1 L_nob0
  s_barrier
L_nob0:
  buffer_load_dwordx4 v[72:75], v3, s[28:31], s36 offen nt
  buffer_load_dwordx4 v[76:79], v4, s[28:31], s36 offen nt
  buffer_load_dwordx4 v[80:83], v1, s[28:31], s37 offen nt
  buffer_load_dwordx4 v[84:87], v2, s[28:31], s37 offen nt
  buffer_load_dwordx4 v[88:91], v3, s[28:31], s37 offen nt
  buffer_load_dwordx4 v[92:95], v4, s[28:31], s37 offen nt
  buffer_load_dwordx4 v[96:99], v1, s[28:31], s38 offen nt
  buffer_load_dwordx4 v[100:103], v2, s[28:31], s38 offen nt
  buffer_load_dwordx4 v[104:107], v3, s[28:31], s38 offen nt
  buffer_load_dwordx4 v[108:111], v4, s[28:31], s38 offen nt
  buffer_load_dwordx4 v[112:115], v1, s[28:31], s39 offen nt
  buffer_load_dwordx4 v[116:119], v2, s[28:31], s39 offen nt
  buffer_load_dwordx4 v[120:123], v3, s[28:31], s39 offen nt
  buffer_load_dwordx4 v[124:127], v4, s[28:31], s39 offen nt
  s_setprio 1
  s_cmp_lt_u32 s60, 2
  s_cbranch_scc1 L_qgather
L_qgdone:
  buffer_load_dwordx4 v[16:19], v1, s[32:35], s36 offen nt
  buffer_load_dwordx4 v[20:23], v2, s[32:35], s36 offen nt
  s_cmp_lg_u32 s60, 12
  s_cbranch_scc1 L_notk
  v_mov_b32 v5, 0
  ds_read_b32 v6, v5 offset:528
  s_bfe_u32 s77, s3, 0x30003
  s_mul_i32 s73, s77, 4352
  s_add_u32 s73, s73, 696320
  s_waitcnt lgkmcnt(0)
  v_readfirstlane_b32 s76, v6
  s_mov_b32 s64, 1
  s_cmp_lg_u32 s76, 1
  s_cbranch_scc1 L_notk
  s_atomic_add s64, s[26:27], s73 glc
  s_load_dword s63, s[24:25], 128
L_notk:
  buffer_load_dwordx4 v[24:27], v3, s[32:35], s36 offen nt
  buffer_load_dwordx4 v[28:31], v4, s[32:35], s36 offen nt
  buffer_load_dwordx4 v[32:35], v1, s[32:35], s37 offen nt
  buffer_load_dwordx4 v[36:39], v2, s[32:35], s37 offen nt
  buffer_load_dwordx4 v[40:43], v3, s[32:35], s37 offen nt
  buffer_load_dwordx4 v[44:47], v4, s[32:35], s37 offen nt
  buffer_load_dwordx4 v[48:51], v1, s[32:35], s38 offen nt
  buffer_load_dwordx4 v[52:55], v2, s[32:35], s38 offen nt
  buffer_load_dwordx4 v[56:59], v3, s[32:35], s38 offen nt
  buffer_load_dwordx4 v[60:63], v4, s[32:35], s38 offen nt
  s_setprio 1
  v_mov_b32 v5, 0
  s_cmp_eq_u32 s60, 12
  s_cbranch_scc1 L_ticket
L_tkdone:
  v_and_b32 v6, 15, v0
  v_lshlrev_b32 v6, 4, v6
  s_mov_b32 s65, 200000
  s_branch Lpoll7_in
Lpoll7:
  s_sleep 4
  s_sub_u32 s65, s65, 1
  s_cbranch_scc1 Lpoll7_out
Lpoll7_in:
  ds_read_b32 v7, v5 offset:524
  s_waitcnt lgkmcnt(0)
Lpoll7_ck:
  v_cmp_gt_u32 vcc, 2, v7
  s_cbranch_vccnz Lpoll7
Lpoll7_out:
  ds_read_b128 v[12:15], v6 offset:0
  v_mov_b32 v8, 0
  v_mov_b32 v9, 0
  v_mov_b32 v10, 0
  v_mov_b32 v11, 0
  s_waitcnt vmcnt(24) lgkmcnt(0)
  v_dot2c_f32_bf16 v8, v64, v12
  v_dot2c_f32_bf16 v9, v68, v12
  v_dot2c_f32_bf16 v10, v72, v12
  v_dot2c_f32_bf16 v11, v76, v12
  v_dot2c_f32_bf16 v8, v65, v13
  v_dot2c_f32_bf16 v9, v69, v13
  v_dot2c_f32_bf16 v10, v73, v13
  v_dot2c_f32_bf16 v11, v77, v13
  v_dot2c_f32_bf16 v8, v66, v14
  v_dot2c_f32_bf16 v9, v70, v14
  v_dot2c_f32_bf16 v10, v74, v14
  v_dot2c_f32_bf16 v11, v78, v14
  v_dot2c_f32_bf16 v8, v67, v15
  v_dot2c_f32_bf16 v9, v71, v15
  v_dot2c_f32_bf16 v10, v75, v15
  v_dot2c_f32_bf16 v11, v79, v15
  s_setprio 2
  buffer_load_dwordx4 v[64:67], v1, s[32:35], s39 offen nt
  buffer_load_dwordx4 v[68:71], v2, s[32:35], s39 offen nt
  buffer_load_dwordx4 v[72:75], v3, s[32:35], s39 offen nt
  buffer_load_dwordx4 v[76:79], v4, s[32:35], s39 offen nt
  s_setprio 1
  v_mov_b32 v4, 0
  v_mov_b32 v5, 0
  v_mov_b32 v6, 0
  v_mov_b32 v7, 0
  s_waitcnt vmcnt(24)
  v_dot2c_f32_bf16 v4, v80, v12
  v_dot2c_f32_bf16 v5, v84, v12
  v_dot2c_f32_bf16 v6, v88, v12
  v_dot2c_f32_bf16 v7, v92, v12
  v_dot2c_f32_bf16 v4, v81, v13
  v_dot2c_f32_bf16 v5, v85, v13
  v_dot2c_f32_bf16 v6, v89, v13
  v_dot2c_f32_bf16 v7, v93, v13
  v_dot2c_f32_bf16 v4, v82, v14
  v_dot2c_f32_bf16 v5, v86, v14
  v_dot2c_f32_bf16 v6, v90, v14
  v_dot2c_f32_bf16 v7, v94, v14
  v_dot2c_f32_bf16 v4, v83, v15
  v_dot2c_f32_bf16 v5, v87, v15
  v_dot2c_f32_bf16 v6, v91, v15
  v_dot2c_f32_bf16 v7, v95, v15
  v_mov_b32 v80, 0
  v_mov_b32 v81, 0
  v_mov_b32 v82, 0
  v_mov_b32 v83, 0
  v_mov_b32 v84, 0
  v_mov_b32 v85, 0
  v_mov_b32 v86, 0
  v_mov_b32 v87, 0
  s_waitcnt vmcnt(16)
  v_dot2c_f32_bf16 v80, v96, v12
  v_dot2c_f32_bf16 v81, v100, v12
  v_dot2c_f32_bf16 v82, v104, v12
  v_dot2c_f32_bf16 v83, v108, v12
  v_dot2c_f32_bf16 v84, v112, v12
  v_dot2c_f32_bf16 v85, v116, v12
  v_dot2c_f32_bf16 v86, v120, v12
  v_dot2c_f32_bf16 v87, v124, v12
  v_dot2c_f32_bf16 v80, v97, v13
  v_dot2c_f32_bf16 v81, v101, v13
  v_dot2c_f32_bf16 v82, v105, v13
  v_dot2c_f32_bf16 v83, v109, v13
  v_dot2c_f32_bf16 v84, v113, v13
  v_dot2c_f32_bf16 v85, v117, v13
  v_dot2c_f32_bf16 v86, v121, v13
  v_dot2c_f32_bf16 v87, v125, v13
  v_dot2c_f32_bf16 v80, v98, v14
  v_dot2c_f32_bf16 v81, v102, v14
  v_dot2c_f32_bf16 v82, v106, v14
  v_dot2c_f32_bf16 v83, v110, v14
  v_dot2c_f32_bf16 v84, v114, v14
  v_dot2c_f32_bf16 v85, v118, v14
  v_dot2c_f32_bf16 v86, v122, v14
  v_dot2c_f32_bf16 v87, v126, v14
  v_dot2c_f32_bf16 v80, v99, v15
  v_dot2c_f32_bf16 v81, v103, v15
  v_dot2c_f32_bf16 v82, v107, v15
  v_dot2c_f32_bf16 v83, v111, v15
  v_dot2c_f32_bf16 v84, v115, v15
  v_dot2c_f32_bf16 v85, v119, v15
  v_dot2c_f32_bf16 v86, v123, v15
  v_dot2c_f32_bf16 v87, v127, v15
  v_add_f32_dpp v8, v8, v8 row_ror:8 row_mask:0xf bank_mask:0x3
  v_add_f32_dpp v9, v9, v9 row_ror:8 row_mask:0xf bank_mask:0x3
  v_add_f32_dpp v10, v10, v10 row_ror:8 row_mask:0xf bank_mask:0x3
  v_add_f32_dpp v11, v11, v11 row_ror:8 row_mask:0xf bank_mask:0x3
  v_add_f32_dpp v4, v4, v4 row_ror:8 row_mask:0xf bank_mask:0x3
  v_add_f32_dpp v5, v5, v5 row_ror:8 row_mask:0xf bank_mask:0x3
  v_add_f32_dpp v6, v6, v6 row_ror:8 row_mask:0xf bank_mask:0x3
  v_add_f32_dpp v7, v7, v7 row_ror:8 row_mask:0xf bank_mask:0x3
  v_add_f32_dpp v8, v80, v80 row_ror:8 row_mask:0xf bank_mask:0xc
  v_add_f32_dpp v9, v81, v81 row_ror:8 row_mask:0xf bank_mask:0xc
  v_add_f32_dpp v10, v82, v82 row_ror:8 row_mask:0xf bank_mask:0xc
  v_add_f32_dpp v11, v83, v83 row_ror:8 row_mask:0xf bank_mask:0xc
  v_add_f32_dpp v4, v84, v84 row_ror:8 row_mask:0xf bank_mask:0xc
  v_add_f32_dpp v5, v85, v85 row_ror:8 row_mask:0xf bank_mask:0xc
  v_add_f32_dpp v6, v86, v86 row_ror:8 row_mask:0xf bank_mask:0xc
  v_add_f32_dpp v7, v87, v87 row_ror:8 row_mask:0xf bank_mask:0xc
  v_add_f32_dpp v8, v8, v8 row_half_mirror row_mask:0xf bank_mask:0x5
  v_add_f32_dpp v9, v9, v9 row_half_mirror row_mask:0xf bank_mask:0x5
  v_add_f32_dpp v10, v10, v10 row_half_mirror row_mask:0xf bank_mask:0x5
  v_add_f32_dpp v11, v11, v11 row_half_mirror row_mask:0xf bank_mask:0x5
  v_add_f32_dpp v8, v4, v4 row_half_mirror row_mask:0xf bank_mask:0xa
  v_add_f32_dpp v9, v5, v5 row_half_mirror row_mask:0xf bank_mask:0xa
  v_add_f32_dpp v10, v6, v6 row_half_mirror row_mask:0xf bank_mask:0xa
  v_add_f32_dpp v11, v7, v7 row_half_mirror row_mask:0xf bank_mask:0xa
  v_add_f32_dpp v8, v8, v8 quad_perm:[1,0,3,2] row_mask:0xf bank_mask:0xf
  v_add_f32_dpp v9, v9, v9 quad_perm:[1,0,3,2] row_mask:0xf bank_mask:0xf
  v_add_f32_dpp v10, v10, v10 quad_perm:[1,0,3,2] row_mask:0xf bank_mask:0xf
  v_add_f32_dpp v11, v11, v11 quad_perm:[1,0,3,2] row_mask:0xf bank_mask:0xf
  v_add_f32_dpp v8, v8, v8 quad_perm:[2,3,0,1] row_mask:0xf bank_mask:0xf
  v_add_f32_dpp v9, v9, v9 quad_perm:[2,3,0,1] row_mask:0xf bank_mask:0xf
  v_add_f32_dpp v10, v10, v10 quad_perm:[2,3,0,1] row_mask:0xf bank_mask:0xf
  v_add_f32_dpp v11, v11, v11 quad_perm:[2,3,0,1] row_mask:0xf bank_mask:0xf
  v_cvt_pk_bf16_f32 v8, 0, v8
  v_cvt_pk_bf16_f32 v9, 0, v9
  v_cvt_pk_bf16_f32 v10, 0, v10
  v_cvt_pk_bf16_f32 v11, 0, v11
  v_mul_f32 v8, 0x3db504f3, v8
  v_mul_f32 v9, 0x3db504f3, v9
  v_mul_f32 v10, 0x3db504f3, v10
  v_mul_f32 v11, 0x3db504f3, v11
  v_cvt_pk_bf16_f32 v8, 0, v8
  v_cvt_pk_bf16_f32 v9, 0, v9
  v_cvt_pk_bf16_f32 v10, 0, v10
  v_cvt_pk_bf16_f32 v11, 0, v11
  v_max3_f32 v12, v8, v9, v10
  v_max_f32 v12, v12, v11
  s_nop 1
  v_max_f32_dpp v12, v12, v12 row_ror:4 row_mask:0xf bank_mask:0xf
  s_nop 1
  v_max_f32_dpp v12, v12, v12 row_ror:8 row_mask:0xf bank_mask:0xf
  v_mov_b32 v13, v12
  s_nop 1
  v_permlane16_swap_b32 v12, v13
  v_max_f32 v12, v12, v13
  v_mov_b32 v13, v12
  s_nop 1
  v_permlane32_swap_b32 v12, v13
  v_max_f32 v12, v12, v13
  v_sub_f32 v8, v8, v12
  v_sub_f32 v9, v9, v12
  v_sub_f32 v10, v10, v12
  v_sub_f32 v11, v11, v12
  v_mul_f32 v8, 0x3fb8aa3b, v8
  v_mul_f32 v9, 0x3fb8aa3b, v9
  v_mul_f32 v10, 0x3fb8aa3b, v10
  v_mul_f32 v11, 0x3fb8aa3b, v11
  v_exp_f32 v8, v8
  v_exp_f32 v9, v9
  v_exp_f32 v10, v10
  v_exp_f32 v11, v11
  v_mul_f32 v12, 0x3fb8aa3b, v12
  v_add_f32 v13, v8, v9
  v_add_f32 v14, v10, v11
  v_add_f32 v13, v13, v14
  s_nop 1
  v_add_f32_dpp v13, v13, v13 row_ror:4 row_mask:0xf bank_mask:0xf
  s_nop 1
  v_add_f32_dpp v13, v13, v13 row_ror:8 row_mask:0xf bank_mask:0xf
  v_mov_b32 v14, v13
  s_nop 1
  v_permlane16_swap_b32 v13, v14
  v_add_f32 v13, v13, v14
  v_mov_b32 v14, v13
  s_nop 1
  v_permlane32_swap_b32 v13, v14
  v_add_f32 v13, v13, v14
  s_lshl_b32 s73, s60, 3
  v_mov_b32 v14, s73
  v_mov_b32 v15, 1
  v_mov_b32 v5, 0
  s_mov_b64 exec, 1
  ds_write_b64 v14, v[12:13] offset:256
  ds_add_rtn_u32 v14, v5, v15 offset:520
  s_mov_b64 exec, -1
  v_cvt_pk_bf16_f32 v88, v8, 0
  v_cvt_pk_bf16_f32 v92, 0, v8
  v_cvt_pk_bf16_f32 v89, v9, 0
  v_cvt_pk_bf16_f32 v93, 0, v9
  v_cvt_pk_bf16_f32 v90, v10, 0
  v_cvt_pk_bf16_f32 v94, 0, v10
  v_cvt_pk_bf16_f32 v91, v11, 0
  v_cvt_pk_bf16_f32 v95, 0, v11
  v_and_b32 v2, 15, v0
  v_bfe_u32 v3, v0, 4, 2
  v_and_b32 v6, 7, v0
  v_lshl_add_u32 v6, v6, 2, v3
  v_lshlrev_b32 v6, 4, v6
  v_bfe_u32 v7, v0, 3, 1
  v_lshl_add_u32 v6, v7, 3, v6
  s_lshl_b32 s73, s60, 9
  v_add_u32 v6, s73, v6
  v_and_b32 v8, 31, v0
  v_lshlrev_b32 v8, 4, v8
  v_bfe_u32 v9, v0, 5, 1
  v_lshl_add_u32 v7, v9, 12, v8
  v_lshlrev_b32 v9, 5, v9
  v_and_b32 v8, 63, v0
  v_lshlrev_b32 v8, 3, v8
  v_mov_b32 v96, 0
  v_mov_b32 v97, 0
  v_mov_b32 v98, 0
  v_mov_b32 v99, 0
  v_mov_b32 v100, 0
  v_mov_b32 v101, 0
  v_mov_b32 v102, 0
  v_mov_b32 v103, 0
  s_waitcnt lgkmcnt(0)
  v_readfirstlane_b32 s73, v14
  s_nop 0
  s_cmp_eq_u32 s73, 15
  s_cbranch_scc1 L_stats
L_statsdone:
  s_waitcnt vmcnt(15)
  v_dot2c_f32_bf16_dpp v96, v88, v16 row_newbcast:0 row_mask:0xf bank_mask:0xf
  v_dot2c_f32_bf16_dpp v97, v92, v16 row_newbcast:0 row_mask:0xf bank_mask:0xf
  v_dot2c_f32_bf16_dpp v98, v88, v17 row_newbcast:0 row_mask:0xf bank_mask:0xf
  v_dot2c_f32_bf16_dpp v99, v92, v17 row_newbcast:0 row_mask:0xf bank_mask:0xf
  v_dot2c_f32_bf16_dpp v100, v88, v18 row_newbcast:0 row_mask:0xf bank_mask:0xf
  v_dot2c_f32_bf16_dpp v101, v92, v18 row_newbcast:0 row_mask:0xf bank_mask:0xf
  v_dot2c_f32_bf16_dpp v102, v88, v19 row_newbcast:0 row_mask:0xf bank_mask:0xf
  v_dot2c_f32_bf16_dpp v103, v92, v19 row_newbcast:0 row_mask:0xf bank_mask:0xf
  s_waitcnt vmcnt(14)
  v_dot2c_f32_bf16_dpp v96, v89, v20 row_newbcast:0 row_mask:0xf bank_mask:0xf
  v_dot2c_f32_bf16_dpp v97, v93, v20 row_newbcast:0 row_mask:0xf bank_mask:0xf
  v_dot2c_f32_bf16_dpp v98, v89, v21 row_newbcast:0 row_mask:0xf bank_mask:0xf
  v_dot2c_f32_bf16_dpp v99, v93, v21 row_newbcast:0 row_mask:0xf bank_mask:0xf
  v_dot2c_f32_bf16_dpp v100, v89, v22 row_newbcast:0 row_mask:0xf bank_mask:0xf
  v_dot2c_f32_bf16_dpp v101, v93, v22 row_newbcast:0 row_mask:0xf bank_mask:0xf
  v_dot2c_f32_bf16_dpp v102, v89, v23 row_newbcast:0 row_mask:0xf bank_mask:0xf
  v_dot2c_f32_bf16_dpp v103, v93, v23 row_newbcast:0 row_mask:0xf bank_mask:0xf
  s_waitcnt vmcnt(13)
  v_dot2c_f32_bf16_dpp v96, v90, v24 row_newbcast:0 row_mask:0xf bank_mask:0xf
  v_dot2c_f32_bf16_dpp v97, v94, v24 row_newbcast:0 row_mask:0xf bank_mask:0xf
  v_dot2c_f32_bf16_dpp v98, v90, v25 row_newbcast:0 row_mask:0xf bank_mask:0xf
  v_dot2c_f32_bf16_dpp v99, v94, v25 row_newbcast:0 row_mask:0xf bank_mask:0xf
  v_dot2c_f32_bf16_dpp v100, v90, v26 row_newbcast:0 row_mask:0xf bank_mask:0xf
  v_dot2c_f32_bf16_dpp v101, v94, v26 row_newbcast:0 row_mask:0xf bank_mask:0xf
  v_dot2c_f32_bf16_dpp v102, v90, v27 row_newbcast:0 row_mask:0xf bank_mask:0xf
  v_dot2c_f32_bf16_dpp v103, v94, v27 row_newbcast:0 row_mask:0xf bank_mask:0xf
  s_waitcnt vmcnt(12)
  v_dot2c_f32_bf16_dpp v96, v91, v28 row_newbcast:0 row_mask:0xf bank_mask:0xf
  v_dot2c_f32_bf16_dpp v97, v95, v28 row_newbcast:0 row_mask:0xf bank_mask:0xf
  v_dot2c_f32_bf16_dpp v98, v91, v29 row_newbcast:0 row_mask:0xf bank_mask:0xf
  v_dot2c_f32_bf16_dpp v99, v95, v29 row_newbcast:0 row_mask:0xf bank_mask:0xf
  v_dot2c_f32_bf16_dpp v100, v91, v30 row_newbcast:0 row_mask:0xf bank_mask:0xf
  v_dot2c_f32_bf16_dpp v101, v95, v30 row_newbcast:0 row_mask:0xf bank_mask:0xf
  v_dot2c_f32_bf16_dpp v102, v91, v31 row_newbcast:0 row_mask:0xf bank_mask:0xf
  v_dot2c_f32_bf16_dpp v103, v95, v31 row_newbcast:0 row_mask:0xf bank_mask:0xf
  s_waitcnt vmcnt(11)
  v_dot2c_f32_bf16_dpp v96, v88, v32 row_newbcast:4 row_mask:0xf bank_mask:0xf
  v_dot2c_f32_bf16_dpp v97, v92, v32 row_newbcast:4 row_mask:0xf bank_mask:0xf
  v_dot2c_f32_bf16_dpp v98, v88, v33 row_newbcast:4 row_mask:0xf bank_mask:0xf
  v_dot2c_f32_bf16_dpp v99, v92, v33 row_newbcast:4 row_mask:0xf bank_mask:0xf
  v_dot2c_f32_bf16_dpp v100, v88, v34 row_newbcast:4 row_mask:0xf bank_mask:0xf
  v_dot2c_f32_bf16_dpp v101, v92, v34 row_newbcast:4 row_mask:0xf bank_mask:0xf
  v_dot2c_f32_bf16_dpp v102, v88, v35 row_newbcast:4 row_mask:0xf bank_mask:0xf
  v_dot2c_f32_bf16_dpp v103, v92, v35 row_newbcast:4 row_mask:0xf bank_mask:0xf
  s_waitcnt vmcnt(10)
  v_dot2c_f32_bf16_dpp v96, v89, v36 row_newbcast:4 row_mask:0xf bank_mask:0xf
  v_dot2c_f32_bf16_dpp v97, v93, v36 row_newbcast:4 row_mask:0xf bank_mask:0xf
  v_dot2c_f32_bf16_dpp v98, v89, v37 row_newbcast:4 row_mask:0xf bank_mask:0xf
  v_dot2c_f32_bf16_dpp v99, v93, v37 row_newbcast:4 row_mask:0xf bank_mask:0xf
  v_dot2c_f32_bf16_dpp v100, v89, v38 row_newbcast:4 row_mask:0xf bank_mask:0xf
  v_dot2c_f32_bf16_dpp v101, v93, v38 row_newbcast:4 row_mask:0xf bank_mask:0xf
  v_dot2c_f32_bf16_dpp v102, v89, v39 row_newbcast:4 row_mask:0xf bank_mask:0xf
  v_dot2c_f32_bf16_dpp v103, v93, v39 row_newbcast:4 row_mask:0xf bank_mask:0xf
  s_waitcnt vmcnt(9)
  v_dot2c_f32_bf16_dpp v96, v90, v40 row_newbcast:4 row_mask:0xf bank_mask:0xf
  v_dot2c_f32_bf16_dpp v97, v94, v40 row_newbcast:4 row_mask:0xf bank_mask:0xf
  v_dot2c_f32_bf16_dpp v98, v90, v41 row_newbcast:4 row_mask:0xf bank_mask:0xf
  v_dot2c_f32_bf16_dpp v99, v94, v41 row_newbcast:4 row_mask:0xf bank_mask:0xf
  v_dot2c_f32_bf16_dpp v100, v90, v42 row_newbcast:4 row_mask:0xf bank_mask:0xf
  v_dot2c_f32_bf16_dpp v101, v94, v42 row_newbcast:4 row_mask:0xf bank_mask:0xf
  v_dot2c_f32_bf16_dpp v102, v90, v43 row_newbcast:4 row_mask:0xf bank_mask:0xf
  v_dot2c_f32_bf16_dpp v103, v94, v43 row_newbcast:4 row_mask:0xf bank_mask:0xf
  s_waitcnt vmcnt(8)
  v_dot2c_f32_bf16_dpp v96, v91, v44 row_newbcast:4 row_mask:0xf bank_mask:0xf
  v_dot2c_f32_bf16_dpp v97, v95, v44 row_newbcast:4 row_mask:0xf bank_mask:0xf
  v_dot2c_f32_bf16_dpp v98, v91, v45 row_newbcast:4 row_mask:0xf bank_mask:0xf
  v_dot2c_f32_bf16_dpp v99, v95, v45 row_newbcast:4 row_mask:0xf bank_mask:0xf
  v_dot2c_f32_bf16_dpp v100, v91, v46 row_newbcast:4 row_mask:0xf bank_mask:0xf
  v_dot2c_f32_bf16_dpp v101, v95, v46 row_newbcast:4 row_mask:0xf bank_mask:0xf
  v_dot2c_f32_bf16_dpp v102, v91, v47 row_newbcast:4 row_mask:0xf bank_mask:0xf
  v_dot2c_f32_bf16_dpp v103, v95, v47 row_newbcast:4 row_mask:0xf bank_mask:0xf
  s_waitcnt vmcnt(7)
  v_dot2c_f32_bf16_dpp v96, v88, v48 row_newbcast:8 row_mask:0xf bank_mask:0xf
  v_dot2c_f32_bf16_dpp v97, v92, v48 row_newbcast:8 row_mask:0xf bank_mask:0xf
  v_dot2c_f32_bf16_dpp v98, v88, v49 row_newbcast:8 row_mask:0xf bank_mask:0xf
  v_dot2c_f32_bf16_dpp v99, v92, v49 row_newbcast:8 row_mask:0xf bank_mask:0xf
  v_dot2c_f32_bf16_dpp v100, v88, v50 row_newbcast:8 row_mask:0xf bank_mask:0xf
  v_dot2c_f32_bf16_dpp v101, v92, v50 row_newbcast:8 row_mask:0xf bank_mask:0xf
  v_dot2c_f32_bf16_dpp v102, v88, v51 row_newbcast:8 row_mask:0xf bank_mask:0xf
  v_dot2c_f32_bf16_dpp v103, v92, v51 row_newbcast:8 row_mask:0xf bank_mask:0xf
  s_waitcnt vmcnt(6)
  v_dot2c_f32_bf16_dpp v96, v89, v52 row_newbcast:8 row_mask:0xf bank_mask:0xf
  v_dot2c_f32_bf16_dpp v97, v93, v52 row_newbcast:8 row_mask:0xf bank_mask:0xf
  v_dot2c_f32_bf16_dpp v98, v89, v53 row_newbcast:8 row_mask:0xf bank_mask:0xf
  v_dot2c_f32_bf16_dpp v99, v93, v53 row_newbcast:8 row_mask:0xf bank_mask:0xf
  v_dot2c_f32_bf16_dpp v100, v89, v54 row_newbcast:8 row_mask:0xf bank_mask:0xf
  v_dot2c_f32_bf16_dpp v101, v93, v54 row_newbcast:8 row_mask:0xf bank_mask:0xf
  v_dot2c_f32_bf16_dpp v102, v89, v55 row_newbcast:8 row_mask:0xf bank_mask:0xf
  v_dot2c_f32_bf16_dpp v103, v93, v55 row_newbcast:8 row_mask:0xf bank_mask:0xf
  s_waitcnt vmcnt(5)
  v_dot2c_f32_bf16_dpp v96, v90, v56 row_newbcast:8 row_mask:0xf bank_mask:0xf
  v_dot2c_f32_bf16_dpp v97, v94, v56 row_newbcast:8 row_mask:0xf bank_mask:0xf
  v_dot2c_f32_bf16_dpp v98, v90, v57 row_newbcast:8 row_mask:0xf bank_mask:0xf
  v_dot2c_f32_bf16_dpp v99, v94, v57 row_newbcast:8 row_mask:0xf bank_mask:0xf
  v_dot2c_f32_bf16_dpp v100, v90, v58 row_newbcast:8 row_mask:0xf bank_mask:0xf
  v_dot2c_f32_bf16_dpp v101, v94, v58 row_newbcast:8 row_mask:0xf bank_mask:0xf
  v_dot2c_f32_bf16_dpp v102, v90, v59 row_newbcast:8 row_mask:0xf bank_mask:0xf
  v_dot2c_f32_bf16_dpp v103, v94, v59 row_newbcast:8 row_mask:0xf bank_mask:0xf
  s_waitcnt vmcnt(4)
  v_dot2c_f32_bf16_dpp v96, v91, v60 row_newbcast:8 row_mask:0xf bank_mask:0xf
  v_dot2c_f32_bf16_dpp v97, v95, v60 row_newbcast:8 row_mask:0xf bank_mask:0xf
  v_dot2c_f32_bf16_dpp v98, v91, v61 row_newbcast:8 row_mask:0xf bank_mask:0xf
  v_dot2c_f32_bf16_dpp v99, v95, v61 row_newbcast:8 row_mask:0xf bank_mask:0xf
  v_dot2c_f32_bf16_dpp v100, v91, v62 row_newbcast:8 row_mask:0xf bank_mask:0xf
  v_dot2c_f32_bf16_dpp v101, v95, v62 row_newbcast:8 row_mask:0xf bank_mask:0xf
  v_dot2c_f32_bf16_dpp v102, v91, v63 row_newbcast:8 row_mask:0xf bank_mask:0xf
  v_dot2c_f32_bf16_dpp v103, v95, v63 row_newbcast:8 row_mask:0xf bank_mask:0xf
  s_waitcnt vmcnt(3)
  v_dot2c_f32_bf16_dpp v96, v88, v64 row_newbcast:12 row_mask:0xf bank_mask:0xf
  v_dot2c_f32_bf16_dpp v97, v92, v64 row_newbcast:12 row_mask:0xf bank_mask:0xf
  v_dot2c_f32_bf16_dpp v98, v88, v65 row_newbcast:12 row_mask:0xf bank_mask:0xf
  v_dot2c_f32_bf16_dpp v99, v92, v65 row_newbcast:12 row_mask:0xf bank_mask:0xf
  v_dot2c_f32_bf16_dpp v100, v88, v66 row_newbcast:12 row_mask:0xf bank_mask:0xf
  v_dot2c_f32_bf16_dpp v101, v92, v66 row_newbcast:12 row_mask:0xf bank_mask:0xf
  v_dot2c_f32_bf16_dpp v102, v88, v67 row_newbcast:12 row_mask:0xf bank_mask:0xf
  v_dot2c_f32_bf16_dpp v103, v92, v67 row_newbcast:12 row_mask:0xf bank_mask:0xf
  s_waitcnt vmcnt(2)
  v_dot2c_f32_bf16_dpp v96, v89, v68 row_newbcast:12 row_mask:0xf bank_mask:0xf
  v_dot2c_f32_bf16_dpp v97, v93, v68 row_newbcast:12 row_mask:0xf bank_mask:0xf
  v_dot2c_f32_bf16_dpp v98, v89, v69 row_newbcast:12 row_mask:0xf bank_mask:0xf
  v_dot2c_f32_bf16_dpp v99, v93, v69 row_newbcast:12 row_mask:0xf bank_mask:0xf
  v_dot2c_f32_bf16_dpp v100, v89, v70 row_newbcast:12 row_mask:0xf bank_mask:0xf
  v_dot2c_f32_bf16_dpp v101, v93, v70 row_newbcast:12 row_mask:0xf bank_mask:0xf
  v_dot2c_f32_bf16_dpp v102, v89, v71 row_newbcast:12 row_mask:0xf bank_mask:0xf
  v_dot2c_f32_bf16_dpp v103, v93, v71 row_newbcast:12 row_mask:0xf bank_mask:0xf
  s_waitcnt vmcnt(1)
  v_dot2c_f32_bf16_dpp v96, v90, v72 row_newbcast:12 row_mask:0xf bank_mask:0xf
  v_dot2c_f32_bf16_dpp v97, v94, v72 row_newbcast:12 row_mask:0xf bank_mask:0xf
  v_dot2c_f32_bf16_dpp v98, v90, v73 row_newbcast:12 row_mask:0xf bank_mask:0xf
  v_dot2c_f32_bf16_dpp v99, v94, v73 row_newbcast:12 row_mask:0xf bank_mask:0xf
  v_dot2c_f32_bf16_dpp v100, v90, v74 row_newbcast:12 row_mask:0xf bank_mask:0xf
  v_dot2c_f32_bf16_dpp v101, v94, v74 row_newbcast:12 row_mask:0xf bank_mask:0xf
  v_dot2c_f32_bf16_dpp v102, v90, v75 row_newbcast:12 row_mask:0xf bank_mask:0xf
  v_dot2c_f32_bf16_dpp v103, v94, v75 row_newbcast:12 row_mask:0xf bank_mask:0xf
  s_waitcnt vmcnt(0)
  v_dot2c_f32_bf16_dpp v96, v91, v76 row_newbcast:12 row_mask:0xf bank_mask:0xf
  v_dot2c_f32_bf16_dpp v97, v95, v76 row_newbcast:12 row_mask:0xf bank_mask:0xf
  v_dot2c_f32_bf16_dpp v98, v91, v77 row_newbcast:12 row_mask:0xf bank_mask:0xf
  v_dot2c_f32_bf16_dpp v99, v95, v77 row_newbcast:12 row_mask:0xf bank_mask:0xf
  v_dot2c_f32_bf16_dpp v100, v91, v78 row_newbcast:12 row_mask:0xf bank_mask:0xf
  v_dot2c_f32_bf16_dpp v101, v95, v78 row_newbcast:12 row_mask:0xf bank_mask:0xf
  v_dot2c_f32_bf16_dpp v102, v91, v79 row_newbcast:12 row_mask:0xf bank_mask:0xf
  v_dot2c_f32_bf16_dpp v103, v95, v79 row_newbcast:12 row_mask:0xf bank_mask:0xf
  v_permlane32_swap_b32 v96, v100
  v_permlane32_swap_b32 v97, v101
  v_permlane32_swap_b32 v98, v102
  v_permlane32_swap_b32 v99, v103
  v_pk_add_f32 v[96:97], v[96:97], v[100:101]
  v_pk_add_f32 v[98:99], v[98:99], v[102:103]
  s_nop 1
  v_permlane16_swap_b32 v96, v98
  v_permlane16_swap_b32 v97, v99
  v_pk_add_f32 v[96:97], v[96:97], v[98:99]
  ds_write_b64 v6, v[96:97] offset:2048
  s_mov_b64 exec, 1
  ds_add_rtn_u32 v16, v5, v15 offset:516
  s_mov_b64 exec, -1
  s_waitcnt lgkmcnt(0)
  v_readfirstlane_b32 s73, v16
  s_nop 0
  s_cmp_lg_u32 s73, 15
  s_cbranch_scc1 L_nopub
  s_setprio 3
  ds_read_b32 v24, v5 offset:448
  ds_read_b128 v[16:19], v9 offset:384
  ds_read_b128 v[20:23], v9 offset:400
  ds_read_b128 v[32:35], v7 offset:2048
  ds_read_b128 v[36:39], v7 offset:2560
  ds_read_b128 v[40:43], v7 offset:3072
  ds_read_b128 v[44:47], v7 offset:3584
  ds_read_b128 v[48:51], v7 offset:4096
  ds_read_b128 v[52:55], v7 offset:4608
  ds_read_b128 v[56:59], v7 offset:5120
  ds_read_b128 v[60:63], v7 offset:5632
  s_waitcnt lgkmcnt(6)
  buffer_store_dword v24, v5, s[44:47], s71 offen sc1
  v_pk_mul_f32 v[32:33], v[32:33], v[16:17] op_sel:[0,0] op_sel_hi:[1,0]
  v_pk_mul_f32 v[34:35], v[34:35], v[16:17] op_sel:[0,0] op_sel_hi:[1,0]
  v_pk_mul_f32 v[36:37], v[36:37], v[16:17] op_sel:[0,1] op_sel_hi:[1,1]
  v_pk_mul_f32 v[38:39], v[38:39], v[16:17] op_sel:[0,1] op_sel_hi:[1,1]
  s_waitcnt lgkmcnt(4)
  v_pk_fma_f32 v[32:33], v[40:41], v[18:19], v[32:33] op_sel:[0,0,0] op_sel_hi:[1,0,1]
  v_pk_fma_f32 v[34:35], v[42:43], v[18:19], v[34:35] op_sel:[0,0,0] op_sel_hi:[1,0,1]
  v_pk_fma_f32 v[36:37], v[44:45], v[18:19], v[36:37] op_sel:[0,1,0] op_sel_hi:[1,1,1]
  v_pk_fma_f32 v[38:39], v[46:47], v[18:19], v[38:39] op_sel:[0,1,0] op_sel_hi:[1,1,1]
  s_waitcnt lgkmcnt(2)
  v_pk_fma_f32 v[32:33], v[48:49], v[20:21], v[32:33] op_sel:[0,0,0] op_sel_hi:[1,0,1]
  v_pk_fma_f32 v[34:35], v[50:51], v[20:21], v[34:35] op_sel:[0,0,0] op_sel_hi:[1,0,1]
  v_pk_fma_f32 v[36:37], v[52:53], v[20:21], v[36:37] op_sel:[0,1,0] op_sel_hi:[1,1,1]
  v_pk_fma_f32 v[38:39], v[54:55], v[20:21], v[38:39] op_sel:[0,1,0] op_sel_hi:[1,1,1]
  s_waitcnt lgkmcnt(0)
  v_pk_fma_f32 v[32:33], v[56:57], v[22:23], v[32:33] op_sel:[0,0,0] op_sel_hi:[1,0,1]
  v_pk_fma_f32 v[34:35], v[58:59], v[22:23], v[34:35] op_sel:[0,0,0] op_sel_hi:[1,0,1]
  v_pk_fma_f32 v[36:37], v[60:61], v[22:23], v[36:37] op_sel:[0,1,0] op_sel_hi:[1,1,1]
  v_pk_fma_f32 v[38:39], v[62:63], v[22:23], v[38:39] op_sel:[0,1,0] op_sel_hi:[1,1,1]
  v_pk_add_f32 v[32:33], v[32:33], v[36:37]
  v_pk_add_f32 v[34:35], v[34:35], v[38:39]
  s_nop 1
  v_permlane32_swap_b32 v32, v34
  v_permlane32_swap_b32 v33, v35
  v_pk_add_f32 v[32:33], v[32:33], v[34:35]
  v_min_u32 v32, -2, v32
  v_min_u32 v33, -2, v33
  buffer_store_dwordx2 v[32:33], v8, s[44:47], s72 offen sc1
L_nopub:
  s_setprio 0
  s_mov_b32 s65, 266666
  s_branch Lpoll8_in
Lpoll8:
  s_sleep 2
  s_sub_u32 s65, s65, 1
  s_cbranch_scc1 Lpoll8_out
Lpoll8_in:
  ds_read_b32 v16, v5 offset:512
  s_waitcnt lgkmcnt(0)
Lpoll8_ck:
  v_cmp_eq_u32 vcc, -1, v16
  s_cbranch_vccnz Lpoll8
Lpoll8_out:
  v_readfirstlane_b32 s64, v16
  s_mov_b32 s58, 0
  s_sub_u32 s57, s64, 30
  s_cmp_lt_u32 s57, 80
  s_cselect_b32 s58, 3, s58
  s_cselect_b32 s56, s57, s56
  s_sub_u32 s57, s64, 130
  s_cmp_lt_u32 s57, 54
  s_cselect_b32 s58, 4, s58
  s_cselect_b32 s56, s57, s56
  s_sub_u32 s57, s64, 0
  s_cmp_lt_u32 s57, 20
  s_cselect_b32 s58, 5, s58
  s_cselect_b32 s56, s57, s56
  s_cmp_eq_u32 s58, 0
  s_cbranch_scc0 Lcont0
  s_endpgm
Lcont0:
  s_mov_b32 s64, s56
  v_mul_u32_u24 v12, 5120, v3
  v_lshl_add_u32 v12, v2, 4, v12
  s_mul_i32 s65, s60, 320
  v_add_u32 v12, s65, v12
  v_and_b32 v1, 3, v0
  v_bfe_u32 v5, v0, 2, 2
  v_lshlrev_b32 v1, 5, v1
  v_lshl_add_u32 v1, v5, 3, v1
  v_and_b32 v4, 3, v0
  v_bfe_u32 v5, v0, 2, 4
  v_mul_u32_u24 v2, 320, v4
  v_lshl_add_u32 v2, v5, 4, v2
  s_mul_i32 s65, s60, 1280
  v_add_u32 v2, s65, v2
  v_lshrrev_b32 v13, 1, v8
  s_cmp_eq_u32 s58, 3
  s_cbranch_scc1 L_p3
  s_cmp_eq_u32 s58, 4
  s_cbranch_scc1 L_p4
  s_branch L_p5
.p2align 12
L_p3:
  s_mul_i32 s76, s64, 0xcccd
  s_lshr_b32 s76, s76, 19
  s_mul_i32 s77, s76, 10
  s_sub_u32 s77, s64, s77
  s_lshr_b32 s71, s60, 2
  s_lshl_b32 s71, s71, 3
  s_add_u32 s73, s76, s71
  s_mul_i32 s70, s73, 163840
  s_lshl_b32 s71, s77, 7
  s_add_u32 s70, s70, s71
  s_sub_u32 s71, 5242880, s70
  s_add_u32 s48, s12, s70
  s_addc_u32 s49, s13, 0
  s_mov_b32 s50, s71
  s_mov_b32 s51, 0x20000
  v_mul_u32_u24 v6, 10240, v3
  s_and_b32 s71, s60, 3
  s_mul_i32 s65, s71, 40960
  v_add3_u32 v8, v6, v1, s65
  s_mov_b32 s68, 2560
  s_mov_b32 s69, 5120
  s_mov_b32 s70, 7680
  buffer_load_dwordx2 v[64:65], v8, s[48:51], 0 offen offset:0 nt
  buffer_load_dwordx2 v[66:67], v8, s[48:51], 0 offen offset:1280 nt
  buffer_load_dwordx2 v[68:69], v8, s[48:51], s68 offen offset:0 nt
  buffer_load_dwordx2 v[70:71], v8, s[48:51], s68 offen offset:1280 nt
  buffer_load_dwordx2 v[72:73], v8, s[48:51], s69 offen offset:0 nt
  buffer_load_dwordx2 v[74:75], v8, s[48:51], s69 offen offset:1280 nt
  buffer_load_dwordx2 v[76:77], v8, s[48:51], s70 offen offset:0 nt
  buffer_load_dwordx2 v[78:79], v8, s[48:51], s70 offen offset:1280 nt
  s_mov_b32 s70, s73
  s_lshl_b32 s71, s71, 7
  s_lshl_b32 s72, s70, 9
  s_add_u32 s72, s72, s71
  v_bfe_u32 v7, v0, 2, 1
  v_bfe_u32 v8, v0, 3, 1
  v_lshlrev_b32 v9, 15, v4
  v_lshl_add_u32 v9, v7, 14, v9
  v_lshl_add_u32 v9, v3, 5, v9
  v_lshl_add_u32 v9, v8, 4, v9
  s_lshl_b32 s73, s70, 7
  s_add_u32 s73, s73, 131072
  v_lshlrev_b32 v10, 13, v4
  v_lshl_add_u32 v10, v7, 12, v10
  s_mul_i32 s74, s76, 10240
  s_mul_i32 s75, s60, 2560
  s_add_u32 s74, s74, s75
  s_mul_i32 s75, s77, 256
  s_add_u32 s74, s74, s75
  s_add_u32 s74, s74, 163840
  s_barrier
  buffer_load_dword v14, v10, s[44:47], s73 offen sc1
  buffer_load_dwordx4 v[20:23], v9, s[44:47], s72 offen offset:0 sc1
  s_waitcnt vmcnt(2)
  v_perm_b32 v96, v66, v64, s66
  v_perm_b32 v97, v70, v68, s66
  v_perm_b32 v98, v74, v72, s66
  v_perm_b32 v99, v78, v76, s66
  v_perm_b32 v100, v66, v64, s67
  v_perm_b32 v101, v70, v68, s67
  v_perm_b32 v102, v74, v72, s67
  v_perm_b32 v103, v78, v76, s67
  v_perm_b32 v104, v67, v65, s66
  v_perm_b32 v105, v71, v69, s66
  v_perm_b32 v106, v75, v73, s66
  v_perm_b32 v107, v79, v77, s66
  v_perm_b32 v108, v67, v65, s67
  v_perm_b32 v109, v71, v69, s67
  v_perm_b32 v110, v75, v73, s67
  v_perm_b32 v111, v79, v77, s67
  s_waitcnt vmcnt(0)
  s_mov_b32 s65, 200000
  s_branch Lpoll9_ck
Lpoll9:
  s_mov_b64 exec, vcc
  s_sleep 1
  s_sub_u32 s65, s65, 1
  s_cbranch_scc1 Lpoll9_out
Lpoll9_in:
  buffer_load_dword v14, v10, s[44:47], s73 offen sc1
  buffer_load_dwordx4 v[20:23], v9, s[44:47], s72 offen offset:0 sc1
  s_waitcnt vmcnt(0)
Lpoll9_ck:
  v_max3_u32 v11, v14, v20, v21
  v_max3_u32 v11, v11, v22, v23
  v_cmp_eq_u32 vcc, -1, v11
  s_cbranch_vccnz Lpoll9
Lpoll9_out:
  s_mov_b64 exec, -1
  v_sub_f32_dpp v16, v14, v14 row_shl:4 row_mask:0xf bank_mask:0xf
  v_subrev_f32_dpp v17, v14, v14 row_shl:4 row_mask:0xf bank_mask:0xf
  v_exp_f32 v16, v16
  v_exp_f32 v17, v17
  v_add_f32 v16, 1.0, v16
  v_add_f32 v17, 1.0, v17
  v_rcp_f32 v16, v16
  v_rcp_f32 v17, v17
  v_mul_f32 v32, v20, v16
  v_mul_f32 v33, v21, v16
  v_mul_f32 v34, v22, v16
  v_mul_f32 v35, v23, v16
  v_fmac_f32_dpp v32, v20, v17 row_shl:4 row_mask:0xf bank_mask:0xf
  v_fmac_f32_dpp v33, v21, v17 row_shl:4 row_mask:0xf bank_mask:0xf
  v_fmac_f32_dpp v34, v22, v17 row_shl:4 row_mask:0xf bank_mask:0xf
  v_fmac_f32_dpp v35, v23, v17 row_shl:4 row_mask:0xf bank_mask:0xf
  v_cvt_pk_bf16_f32 v40, v32, v33
  v_cvt_pk_bf16_f32 v41, v34, v35
  s_nop 0
  v_mov_b32_dpp v42, v40 row_shl:8 row_mask:0xf bank_mask:0xf
  v_mov_b32_dpp v43, v41 row_shl:8 row_mask:0xf bank_mask:0xf
  s_nop 1
  v_mfma_f32_16x16x32_bf16 v[48:51], v[96:99], v[40:43], 0
  v_mfma_f32_16x16x32_bf16 v[52:55], v[100:103], v[40:43], 0
  v_mfma_f32_16x16x32_bf16 v[56:59], v[104:107], v[40:43], 0
  v_mfma_f32_16x16x32_bf16 v[60:63], v[108:111], v[40:43], 0
  s_nop 5
  v_mov_b32_dpp v48, v52 row_shr:4 row_mask:0xf bank_mask:0x2
  v_mov_b32_dpp v49, v53 row_shr:4 row_mask:0xf bank_mask:0x2
  v_mov_b32_dpp v50, v54 row_shr:4 row_mask:0xf bank_mask:0x2
  v_mov_b32_dpp v51, v55 row_shr:4 row_mask:0xf bank_mask:0x2
  v_mov_b32_dpp v48, v56 row_shr:8 row_mask:0xf bank_mask:0x4
  v_mov_b32_dpp v49, v57 row_shr:8 row_mask:0xf bank_mask:0x4
  v_mov_b32_dpp v50, v58 row_shr:8 row_mask:0xf bank_mask:0x4
  v_mov_b32_dpp v51, v59 row_shr:8 row_mask:0xf bank_mask:0x4
  v_mov_b32_dpp v48, v60 row_shr:12 row_mask:0xf bank_mask:0x8
  v_mov_b32_dpp v49, v61 row_shr:12 row_mask:0xf bank_mask:0x8
  v_mov_b32_dpp v50, v62 row_shr:12 row_mask:0xf bank_mask:0x8
  v_mov_b32_dpp v51, v63 row_shr:12 row_mask:0xf bank_mask:0x8
  ds_write_b128 v2, v[48:51] offset:10240
  s_waitcnt lgkmcnt(0)
  s_barrier
  s_cmp_ge_u32 s60, 4
  s_cbranch_scc0 Lcont1
  s_endpgm
Lcont1:
  ds_read_b128 v[16:19], v12 offset:10240
  ds_read_b128 v[20:23], v12 offset:11520
  ds_read_b128 v[24:27], v12 offset:12800
  ds_read_b128 v[28:31], v12 offset:14080
  s_waitcnt lgkmcnt(2)
  v_pk_add_f32 v[16:17], v[16:17], v[20:21]
  v_pk_add_f32 v[18:19], v[18:19], v[22:23]
  s_waitcnt lgkmcnt(0)
  v_pk_add_f32 v[24:25], v[24:25], v[28:29]
  v_pk_add_f32 v[26:27], v[26:27], v[30:31]
  v_pk_add_f32 v[16:17], v[16:17], v[24:25]
  v_pk_add_f32 v[18:19], v[18:19], v[26:27]
  s_nop 1
  v_permlane32_swap_b32 v16, v18
  v_permlane32_swap_b32 v17, v19
  v_pk_add_f32 v[16:17], v[16:17], v[18:19]
  s_nop 1
  v_permlane16_swap_b32 v16, v17
  v_add_f32 v16, v16, v17
  v_min_u32 v16, -2, v16
  buffer_store_dword v16, v13, s[44:47], s74 offen sc1
  s_endpgm
L_p5:
  s_lshl_b32 s70, s64, 6
  s_sub_u32 s71, 2211840, s70
  s_add_u32 s48, s20, s70
  s_addc_u32 s49, s21, 0
  s_mov_b32 s50, s71
  s_mov_b32 s51, 0x20000
  s_cmp_ge_u32 s60, 14
  s_cbranch_scc1 L_p5l
  v_mul_u32_u24 v6, 5120, v3
  s_mul_i32 s65, s60, 163840
  v_lshrrev_b32 v1, 1, v1
  v_add3_u32 v8, v6, v1, s65
  s_mov_b32 s68, 81920
  buffer_load_dword v64, v8, s[48:51], 0 offen offset:0 nt
  buffer_load_dword v65, v8, s[48:51], 0 offen offset:1280 nt
  buffer_load_dword v66, v8, s[48:51], 0 offen offset:2560 nt
  buffer_load_dword v67, v8, s[48:51], 0 offen offset:3840 nt
  buffer_load_dword v68, v8, s[48:51], s68 offen offset:0 nt
  buffer_load_dword v69, v8, s[48:51], s68 offen offset:1280 nt
  buffer_load_dword v70, v8, s[48:51], s68 offen offset:2560 nt
  buffer_load_dword v71, v8, s[48:51], s68 offen offset:3840 nt
  v_add_u32 v8, 20480, v8
  buffer_load_dword v72, v8, s[48:51], 0 offen offset:0 nt
  buffer_load_dword v73, v8, s[48:51], 0 offen offset:1280 nt
  buffer_load_dword v74, v8, s[48:51], 0 offen offset:2560 nt
  buffer_load_dword v75, v8, s[48:51], 0 offen offset:3840 nt
  buffer_load_dword v76, v8, s[48:51], s68 offen offset:0 nt
  buffer_load_dword v77, v8, s[48:51], s68 offen offset:1280 nt
  buffer_load_dword v78, v8, s[48:51], s68 offen offset:2560 nt
  buffer_load_dword v79, v8, s[48:51], s68 offen offset:3840 nt
  v_add_u32 v8, 20480, v8
  buffer_load_dword v80, v8, s[48:51], 0 offen offset:0 nt
  buffer_load_dword v81, v8, s[48:51], 0 offen offset:1280 nt
  buffer_load_dword v82, v8, s[48:51], 0 offen offset:2560 nt
  buffer_load_dword v83, v8, s[48:51], 0 offen offset:3840 nt
  buffer_load_dword v84, v8, s[48:51], s68 offen offset:0 nt
  buffer_load_dword v85, v8, s[48:51], s68 offen offset:1280 nt
  buffer_load_dword v86, v8, s[48:51], s68 offen offset:2560 nt
  buffer_load_dword v87, v8, s[48:51], s68 offen offset:3840 nt
  v_add_u32 v8, 20480, v8
  buffer_load_dword v88, v8, s[48:51], 0 offen offset:0 nt
  buffer_load_dword v89, v8, s[48:51], 0 offen offset:1280 nt
  buffer_load_dword v90, v8, s[48:51], 0 offen offset:2560 nt
  buffer_load_dword v91, v8, s[48:51], 0 offen offset:3840 nt
  buffer_load_dword v92, v8, s[48:51], s68 offen offset:0 nt
  buffer_load_dword v93, v8, s[48:51], s68 offen offset:1280 nt
  buffer_load_dword v94, v8, s[48:51], s68 offen offset:2560 nt
  buffer_load_dword v95, v8, s[48:51], s68 offen offset:3840 nt
L_p5l:
  s_mov_b32 s56, s22
  s_mov_b32 s57, s23
  s_mov_b32 s58, 5120
  s_mov_b32 s59, 0x20000
  s_add_u32 s52, s26, 245760
  s_addc_u32 s53, s27, 0
  s_mov_b32 s54, 13824
  s_mov_b32 s55, 0x20000
  s_add_u32 s36, s26, 262144
  s_addc_u32 s37, s27, 0
  s_mov_b32 s38, 13824
  s_mov_b32 s39, 0x20000
  v_lshlrev_b32 v9, 1, v13
  s_lshl_b32 s72, s60, 10
  v_add_u32 v9, s72, v9
  v_bfe_u32 v5, v0, 3, 1
  v_bfe_u32 v6, v0, 6, 1
  v_lshl_add_u32 v5, v6, 1, v5
  v_and_b32 v6, 7, v0
  v_lshl_add_u32 v7, v3, 3, v6
  v_mul_u32_u24 v10, 640, v5
  v_add_u32 v10, v10, v7
  v_lshlrev_b32 v13, 2, v10
  v_lshlrev_b32 v10, 1, v10
  v_mul_u32_u24 v12, 5120, v3
  v_mul_u32_u24 v5, 320, v5
  v_lshrrev_b32 v7, 1, v6
  v_and_b32 v6, 1, v6
  v_lshl_add_u32 v6, v7, 2, v6
  v_lshl_add_u32 v5, v6, 4, v5
  v_add_u32 v12, v12, v5
  s_lshl_b32 s72, s64, 6
  s_cmp_lt_u32 s60, 14
  s_cbranch_scc1 L_p5w
  buffer_load_ushort v11, v10, s[40:43], s72 offen
  s_lshl_b32 s74, s64, 7
  s_add_u32 s74, s74, 163840
  s_add_u32 s29, s74, 10240
  s_add_u32 s30, s74, 20480
  s_add_u32 s31, s74, 30720
  s_add_u32 s32, s74, 40960
  s_add_u32 s33, s74, 51200
  s_add_u32 s34, s74, 61440
  s_add_u32 s35, s74, 71680
  v_mov_b32 v112, 0
  v_mov_b32 v113, 0
  v_mov_b32 v114, 0
  v_mov_b32 v115, 0
  ds_write_b128 v2, v[112:115] offset:10240
  v_and_b32 v7, 63, v0
  v_lshlrev_b32 v7, 11, v7
  s_and_b32 s78, s64, 3
  s_lshl_b32 s78, s78, 9
  s_mov_b32 s65, 100000
  s_branch Lpoll10_in
Lpoll10:
  s_mov_b64 exec, vcc
  s_sleep 4
  s_sub_u32 s65, s65, 1
  s_cbranch_scc1 Lpoll10_out
Lpoll10_in:
  buffer_load_dword v5, v7, s[44:47], s78 offen sc1
  s_waitcnt vmcnt(0)
Lpoll10_ck:
  v_cmp_eq_u32 vcc, -1, v5
  s_nop 0
  s_bcnt1_i32_b64 s61, vcc
  s_cmp_le_u32 s61, 0
  s_cselect_b64 vcc, 0, vcc
  s_cbranch_vccnz Lpoll10
Lpoll10_out:
  s_mov_b64 exec, -1
  s_mov_b32 s65, 200000
  s_branch Lpoll11_in
Lpoll11:
  s_mov_b64 exec, vcc
  s_sleep 1
  s_sub_u32 s65, s65, 1
  s_cbranch_scc1 Lpoll11_out
Lpoll11_in:
  buffer_load_dword v16, v13, s[44:47], s74 offen sc1
  buffer_load_dword v17, v13, s[44:47], s29 offen sc1
  buffer_load_dword v18, v13, s[44:47], s30 offen sc1
  buffer_load_dword v19, v13, s[44:47], s31 offen sc1
  buffer_load_dword v20, v13, s[44:47], s32 offen sc1
  buffer_load_dword v21, v13, s[44:47], s33 offen sc1
  buffer_load_dword v22, v13, s[44:47], s34 offen sc1
  buffer_load_dword v23, v13, s[44:47], s35 offen sc1
  s_waitcnt vmcnt(0)
Lpoll11_ck:
  v_max3_u32 v7, v16, v17, v18
  v_max3_u32 v7, v7, v19, v20
  v_max3_u32 v7, v7, v21, v22
  v_max_u32 v7, v7, v23
  v_cmp_eq_u32 vcc, -1, v7
  s_cbranch_vccnz Lpoll11
Lpoll11_out:
  s_mov_b64 exec, -1
  v_add_f32 v16, v16, v17
  v_add_f32 v18, v18, v19
  v_add_f32 v20, v20, v21
  v_add_f32 v22, v22, v23
  v_add_f32 v16, v16, v18
  v_add_f32 v20, v20, v22
  v_add_f32 v16, v16, v20
  v_lshlrev_b32 v11, 16, v11
  v_cvt_pk_bf16_f32 v16, 0, v16
  v_add_f32 v11, v11, v16
  v_cvt_pk_bf16_f32 v11, 0, v11
  s_waitcnt lgkmcnt(0)
  s_barrier
  s_barrier
  ds_read_b128 v[16:19], v12 offset:10240
  ds_read_b128 v[20:23], v12 offset:11520
  ds_read_b128 v[24:27], v12 offset:12800
  ds_read_b128 v[28:31], v12 offset:14080
  s_waitcnt lgkmcnt(2)
  v_pk_add_f32 v[16:17], v[16:17], v[20:21]
  v_pk_add_f32 v[18:19], v[18:19], v[22:23]
  s_waitcnt lgkmcnt(0)
  v_pk_add_f32 v[24:25], v[24:25], v[28:29]
  v_pk_add_f32 v[26:27], v[26:27], v[30:31]
  v_pk_add_f32 v[16:17], v[16:17], v[24:25]
  v_pk_add_f32 v[18:19], v[18:19], v[26:27]
  s_nop 1
  v_permlane32_swap_b32 v16, v18
  v_permlane32_swap_b32 v17, v19
  v_pk_add_f32 v[16:17], v[16:17], v[18:19]
  s_nop 1
  v_permlane16_swap_b32 v16, v17
  v_add_f32 v16, v16, v17
  v_cvt_pk_bf16_f32 v16, 0, v16
  v_add_f32 v16, v16, v11
  v_cvt_pk_bf16_f32 v16, v16, v16
  buffer_store_short v16, v10, s[56:59], s72 offen
  s_endpgm
L_p5w:
  s_waitcnt vmcnt(0)
  v_perm_b32 v96, v65, v64, s66
  v_perm_b32 v97, v67, v66, s66
  v_perm_b32 v98, v69, v68, s66
  v_perm_b32 v99, v71, v70, s66
  v_perm_b32 v100, v65, v64, s67
  v_perm_b32 v101, v67, v66, s67
  v_perm_b32 v102, v69, v68, s67
  v_perm_b32 v103, v71, v70, s67
  v_perm_b32 v104, v73, v72, s66
  v_perm_b32 v105, v75, v74, s66
  v_perm_b32 v106, v77, v76, s66
  v_perm_b32 v107, v79, v78, s66
  v_perm_b32 v108, v73, v72, s67
  v_perm_b32 v109, v75, v74, s67
  v_perm_b32 v110, v77, v76, s67
  v_perm_b32 v111, v79, v78, s67
  v_perm_b32 v112, v81, v80, s66
  v_perm_b32 v113, v83, v82, s66
  v_perm_b32 v114, v85, v84, s66
  v_perm_b32 v115, v87, v86, s66
  v_perm_b32 v116, v81, v80, s67
  v_perm_b32 v117, v83, v82, s67
  v_perm_b32 v118, v85, v84, s67
  v_perm_b32 v119, v87, v86, s67
  v_perm_b32 v120, v89, v88, s66
  v_perm_b32 v121, v91, v90, s66
  v_perm_b32 v122, v93, v92, s66
  v_perm_b32 v123, v95, v94, s66
  v_perm_b32 v124, v89, v88, s67
  v_perm_b32 v125, v91, v90, s67
  v_perm_b32 v126, v93, v92, s67
  v_perm_b32 v127, v95, v94, s67
  s_barrier
  s_mov_b32 s65, 200000
  s_branch Lpoll12_in
Lpoll12:
  s_mov_b64 exec, vcc
  s_sub_u32 s65, s65, 1
  s_cbranch_scc1 Lpoll12_out
Lpoll12_in:
  buffer_load_dwordx2 v[32:33], v9, s[52:55], 0 offen sc1
  buffer_load_dwordx2 v[36:37], v9, s[36:39], 0 offen sc1
  buffer_load_dwordx2 v[34:35], v9, s[52:55], 0 offen offset:512 sc1
  buffer_load_dwordx2 v[38:39], v9, s[36:39], 0 offen offset:512 sc1
  s_waitcnt vmcnt(0)
Lpoll12_ck:
  v_max3_u32 v7, v32, v33, v34
  v_max3_u32 v7, v7, v35, v36
  v_max3_u32 v7, v7, v37, v38
  v_max_u32 v7, v7, v39
  v_cmp_eq_u32 vcc, -1, v7
  s_cbranch_vccnz Lpoll12
Lpoll12_out:
  s_mov_b64 exec, -1
  v_lshlrev_b32 v40, 16, v32
  v_and_b32 v41, 0xffff0000, v32
  v_lshlrev_b32 v42, 16, v36
  v_and_b32 v43, 0xffff0000, v36
  v_pk_mul_f32 v[40:41], v[40:41], v[42:43]
  v_cvt_pk_bf16_f32 v16, v40, v41
  v_lshlrev_b32 v44, 16, v33
  v_and_b32 v45, 0xffff0000, v33
  v_lshlrev_b32 v46, 16, v37
  v_and_b32 v47, 0xffff0000, v37
  v_pk_mul_f32 v[44:45], v[44:45], v[46:47]
  v_cvt_pk_bf16_f32 v17, v44, v45
  v_lshlrev_b32 v40, 16, v34
  v_and_b32 v41, 0xffff0000, v34
  v_lshlrev_b32 v42, 16, v38
  v_and_b32 v43, 0xffff0000, v38
  v_pk_mul_f32 v[40:41], v[40:41], v[42:43]
  v_cvt_pk_bf16_f32 v18, v40, v41
  v_lshlrev_b32 v44, 16, v35
  v_and_b32 v45, 0xffff0000, v35
  v_lshlrev_b32 v46, 16, v39
  v_and_b32 v47, 0xffff0000, v39
  v_pk_mul_f32 v[44:45], v[44:45], v[46:47]
  v_cvt_pk_bf16_f32 v19, v44, v45
  v_mov_b32_dpp v20, v16 row_shl:4 row_mask:0xf bank_mask:0xf
  v_mov_b32_dpp v21, v17 row_shl:4 row_mask:0xf bank_mask:0xf
  v_mfma_f32_16x16x32_bf16 v[48:51], v[96:99], v[16:19], 0
  v_mov_b32_dpp v22, v18 row_shl:4 row_mask:0xf bank_mask:0xf
  v_mov_b32_dpp v23, v19 row_shl:4 row_mask:0xf bank_mask:0xf
  v_mfma_f32_16x16x32_bf16 v[52:55], v[100:103], v[16:19], 0
  v_mov_b32_dpp v24, v16 row_shl:8 row_mask:0xf bank_mask:0xf
  v_mov_b32_dpp v25, v17 row_shl:8 row_mask:0xf bank_mask:0xf
  v_mfma_f32_16x16x32_bf16 v[48:51], v[104:107], v[20:23], v[48:51]
  v_mov_b32_dpp v26, v18 row_shl:8 row_mask:0xf bank_mask:0xf
  v_mov_b32_dpp v27, v19 row_shl:8 row_mask:0xf bank_mask:0xf
  v_mfma_f32_16x16x32_bf16 v[52:55], v[108:111], v[20:23], v[52:55]
  v_mov_b32_dpp v28, v16 row_shl:12 row_mask:0xf bank_mask:0xf
  v_mov_b32_dpp v29, v17 row_shl:12 row_mask:0xf bank_mask:0xf
  v_mfma_f32_16x16x32_bf16 v[48:51], v[112:115], v[24:27], v[48:51]
  v_mov_b32_dpp v30, v18 row_shl:12 row_mask:0xf bank_mask:0xf
  v_mov_b32_dpp v31, v19 row_shl:12 row_mask:0xf bank_mask:0xf
  v_mfma_f32_16x16x32_bf16 v[52:55], v[116:119], v[24:27], v[52:55]
  s_nop 0
  v_mfma_f32_16x16x32_bf16 v[48:51], v[120:123], v[28:31], v[48:51]
  v_mfma_f32_16x16x32_bf16 v[52:55], v[124:127], v[28:31], v[52:55]
  s_nop 7
  v_mov_b32_dpp v48, v52 row_shr:4 row_mask:0xf bank_mask:0x2
  v_mov_b32_dpp v49, v53 row_shr:4 row_mask:0xf bank_mask:0x2
  v_mov_b32_dpp v50, v54 row_shr:4 row_mask:0xf bank_mask:0x2
  v_mov_b32_dpp v51, v55 row_shr:4 row_mask:0xf bank_mask:0x2
  ds_write_b128 v2, v[48:51] offset:10240
  s_waitcnt lgkmcnt(0)
  s_barrier
  s_endpgm
.p2align 12
L_p4:
  s_barrier
  s_and_b32 s58, s64, 1
  s_lshr_b32 s57, s64, 1
  s_lshl_b32 s70, s57, 7
  s_sub_u32 s71, 2211840, s70
  s_cmp_eq_u32 s58, 0
  s_cselect_b32 s72, s16, s18
  s_cselect_b32 s73, s17, s19
  s_add_u32 s48, s72, s70
  s_addc_u32 s49, s73, 0
  s_mov_b32 s50, s71
  s_mov_b32 s51, 0x20000
  v_and_b32 v5, 15, v0
  v_mul_u32_u24 v15, 2560, v3
  v_lshl_add_u32 v15, v5, 4, v15
  s_mul_i32 s74, s60, 256
  s_add_u32 s74, s74, 163840
  s_add_u32 s29, s74, 10240
  s_add_u32 s30, s74, 20480
  s_add_u32 s31, s74, 30720
  s_add_u32 s32, s74, 40960
  s_add_u32 s33, s74, 51200
  s_add_u32 s34, s74, 61440
  s_add_u32 s35, s74, 71680
  s_lshl_b32 s72, s60, 7
  s_cmp_ge_u32 s60, 12
  s_cbranch_scc1 L_p4a
  s_cmp_ge_u32 s60, 10
  s_cbranch_scc1 L_p4h
  v_mul_u32_u24 v6, 1280, v3
  v_lshl_add_u32 v6, v5, 3, v6
  buffer_load_dwordx2 v[52:53], v6, s[40:43], s72 offen
L_p4h:
  v_mul_u32_u24 v6, 27648, v3
  s_mul_i32 s65, s60, 110592
  v_add3_u32 v8, v6, v1, s65
  s_mov_b32 s68, 6912
  s_mov_b32 s69, 13824
  s_mov_b32 s70, 20736
  buffer_load_dwordx2 v[64:65], v8, s[48:51], 0 offen offset:0 nt
  buffer_load_dwordx2 v[66:67], v8, s[48:51], 0 offen offset:3456 nt
  buffer_load_dwordx2 v[68:69], v8, s[48:51], s68 offen offset:0 nt
  buffer_load_dwordx2 v[70:71], v8, s[48:51], s68 offen offset:3456 nt
  buffer_load_dwordx2 v[72:73], v8, s[48:51], s69 offen offset:0 nt
  buffer_load_dwordx2 v[74:75], v8, s[48:51], s69 offen offset:3456 nt
  buffer_load_dwordx2 v[76:77], v8, s[48:51], s70 offen offset:0 nt
  buffer_load_dwordx2 v[78:79], v8, s[48:51], s70 offen offset:3456 nt
  s_cmp_ge_u32 s60, 8
  s_cbranch_scc1 L_p4w
  v_add_u32 v9, 1327104, v8
  buffer_load_dwordx2 v[80:81], v9, s[48:51], 0 offen offset:0 nt
  buffer_load_dwordx2 v[82:83], v9, s[48:51], 0 offen offset:3456 nt
  buffer_load_dwordx2 v[84:85], v9, s[48:51], s68 offen offset:0 nt
  buffer_load_dwordx2 v[86:87], v9, s[48:51], s68 offen offset:3456 nt
  buffer_load_dwordx2 v[88:89], v9, s[48:51], s69 offen offset:0 nt
  buffer_load_dwordx2 v[90:91], v9, s[48:51], s69 offen offset:3456 nt
  buffer_load_dwordx2 v[92:93], v9, s[48:51], s70 offen offset:0 nt
  buffer_load_dwordx2 v[94:95], v9, s[48:51], s70 offen offset:3456 nt
L_p4w:
L_p4a:
  v_mul_u32_u24 v6, 1344, v3
  v_lshl_add_u32 v6, v5, 3, v6
  v_add_u32 v6, s72, v6
  v_mul_u32_u24 v14, 1344, v4
  v_lshl_add_u32 v14, v3, 4, v14
  s_lshl_b32 s75, s60, 6
  v_add_u32 v14, s75, v14
  s_and_b32 s75, s60, 3
  s_mul_i32 s76, s75, 1344
  v_add_u32 v8, s76, v13
  s_lshl_b32 s75, s75, 3
  v_mov_b32 v54, s75
  v_bfe_u32 v11, v0, 2, 2
  v_lshlrev_b32 v9, 3, v11
  s_lshl_b32 s70, s57, 9
  s_lshl_b32 s75, s60, 7
  s_add_u32 s70, s70, s75
  s_lshl_b32 s75, s58, 14
  s_add_u32 s70, s70, s75
  s_add_u32 s70, s70, 245760
  v_lshrrev_b32 v10, 3, v13
  v_lshlrev_b32 v10, 2, v10
  v_mul_u32_u24 v12, 3840, v3
  v_mul_u32_u24 v11, 320, v11
  v_lshl_add_u32 v11, v4, 4, v11
  s_lshl_b32 s75, s60, 6
  v_add3_u32 v12, v12, v11, s75
  v_and_b32 v61, 255, v0
  v_lshlrev_b32 v61, 2, v61
  v_mov_b32 v62, 0
  v_mov_b32 v63, 1
  s_cmp_ge_u32 s60, 12
  s_cbranch_scc1 L_p4cs
  v_mov_b32 v56, 0x3f803f80
  v_mov_b32 v57, 0x3f803f80
  v_mov_b32 v58, 0x3f803f80
  v_mov_b32 v59, 0x3f803f80
  s_mov_b64 exec, 1
  ds_add_u32 v62, v63 offset:548
  s_mov_b64 exec, -1
  s_waitcnt vmcnt(0)
  v_lshlrev_b32 v48, 16, v52
  v_and_b32 v49, 0xffff0000, v52
  v_lshlrev_b32 v50, 16, v53
  v_and_b32 v51, 0xffff0000, v53
  v_perm_b32 v96, v66, v64, s66
  v_perm_b32 v97, v70, v68, s66
  v_perm_b32 v98, v74, v72, s66
  v_perm_b32 v99, v78, v76, s66
  v_perm_b32 v100, v66, v64, s67
  v_perm_b32 v101, v70, v68, s67
  v_perm_b32 v102, v74, v72, s67
  v_perm_b32 v103, v78, v76, s67
  v_perm_b32 v104, v67, v65, s66
  v_perm_b32 v105, v71, v69, s66
  v_perm_b32 v106, v75, v73, s66
  v_perm_b32 v107, v79, v77, s66
  v_perm_b32 v108, v67, v65, s67
  v_perm_b32 v109, v71, v69, s67
  v_perm_b32 v110, v75, v73, s67
  v_perm_b32 v111, v79, v77, s67
  v_perm_b32 v112, v82, v80, s66
  v_perm_b32 v113, v86, v84, s66
  v_perm_b32 v114, v90, v88, s66
  v_perm_b32 v115, v94, v92, s66
  v_perm_b32 v116, v82, v80, s67
  v_perm_b32 v117, v86, v84, s67
  v_perm_b32 v118, v90, v88, s67
  v_perm_b32 v119, v94, v92, s67
  v_perm_b32 v120, v83, v81, s66
  v_perm_b32 v121, v87, v85, s66
  v_perm_b32 v122, v91, v89, s66
  v_perm_b32 v123, v95, v93, s66
  v_perm_b32 v124, v83, v81, s67
  v_perm_b32 v125, v87, v85, s67
  v_perm_b32 v126, v91, v89, s67
  v_perm_b32 v127, v95, v93, s67
  v_mfma_f32_16x16x32_bf16 v[64:67], v[96:99], v[56:59], 0
  v_mfma_f32_16x16x32_bf16 v[68:71], v[100:103], v[56:59], 0
  v_mfma_f32_16x16x32_bf16 v[72:75], v[104:107], v[56:59], 0
  v_mfma_f32_16x16x32_bf16 v[76:79], v[108:111], v[56:59], 0
  s_cmp_ge_u32 s60, 8
  s_cbranch_scc1 L_p4o
  v_mfma_f32_16x16x32_bf16 v[64:67], v[112:115], v[56:59], v[64:67]
  v_mfma_f32_16x16x32_bf16 v[68:71], v[116:119], v[56:59], v[68:71]
  v_mfma_f32_16x16x32_bf16 v[72:75], v[120:123], v[56:59], v[72:75]
  v_mfma_f32_16x16x32_bf16 v[76:79], v[124:127], v[56:59], v[76:79]
L_p4o:
  s_nop 4
  s_nop 0
  v_mov_b32_dpp v64, v68 quad_perm:[0,1,2,3] row_mask:0xf bank_mask:0x2
  v_mov_b32_dpp v65, v69 quad_perm:[0,1,2,3] row_mask:0xf bank_mask:0x2
  v_mov_b32_dpp v66, v70 quad_perm:[0,1,2,3] row_mask:0xf bank_mask:0x2
  v_mov_b32_dpp v67, v71 quad_perm:[0,1,2,3] row_mask:0xf bank_mask:0x2
  v_mov_b32_dpp v64, v72 quad_perm:[0,1,2,3] row_mask:0xf bank_mask:0x4
  v_mov_b32_dpp v65, v73 quad_perm:[0,1,2,3] row_mask:0xf bank_mask:0x4
  v_mov_b32_dpp v66, v74 quad_perm:[0,1,2,3] row_mask:0xf bank_mask:0x4
  v_mov_b32_dpp v67, v75 quad_perm:[0,1,2,3] row_mask:0xf bank_mask:0x4
  v_mov_b32_dpp v64, v76 quad_perm:[0,1,2,3] row_mask:0xf bank_mask:0x8
  v_mov_b32_dpp v65, v77 quad_perm:[0,1,2,3] row_mask:0xf bank_mask:0x8
  v_mov_b32_dpp v66, v78 quad_perm:[0,1,2,3] row_mask:0xf bank_mask:0x8
  v_mov_b32_dpp v67, v79 quad_perm:[0,1,2,3] row_mask:0xf bank_mask:0x8
  ds_write_b128 v2, v[64:67] offset:30720
  s_mov_b64 exec, 1
  ds_add_u32 v62, v63 offset:540
  s_mov_b64 exec, -1
  s_cmp_ge_u32 s60, 10
  s_cbranch_scc1 L_p4t
  s_mov_b64 s[4:5], -1
  s_mov_b64 s[6:7], -1
  s_mov_b64 s[8:9], -1
  s_mov_b64 s[10:11], -1
  s_mov_b64 s[12:13], -1
  s_mov_b64 s[14:15], -1
  s_mov_b64 s[16:17], -1
  s_mov_b64 s[18:19], -1
  v_mov_b32 v52, 0x3f80
  v_mov_b32 v53, 0x3f800000
  s_mov_b32 s65, 266666
  s_branch Lpoll13_in
Lpoll13:
  s_sleep 2
  s_sub_u32 s65, s65, 1
  s_cbranch_scc1 Lpoll13_out
Lpoll13_in:
  ds_read_b32 v60, v62 offset:544
  s_waitcnt lgkmcnt(0)
Lpoll13_ck:
  v_cmp_ne_u32 vcc, 1, v60
  s_cbranch_vccnz Lpoll13
Lpoll13_out:
  s_mov_b32 s65, 200000
  s_branch Lq14_in
Lq14:
  v_max3_u32 v64, v16, v17, v18
  v_max_u32 v64, v64, v19
  v_max3_u32 v65, v20, v21, v22
  v_max_u32 v65, v65, v23
  v_max3_u32 v66, v24, v25, v26
  v_max_u32 v66, v66, v27
  v_max3_u32 v67, v28, v29, v30
  v_max_u32 v67, v67, v31
  v_max3_u32 v68, v32, v33, v34
  v_max_u32 v68, v68, v35
  v_max3_u32 v69, v36, v37, v38
  v_max_u32 v69, v69, v39
  v_max3_u32 v70, v40, v41, v42
  v_max_u32 v70, v70, v43
  v_max3_u32 v71, v44, v45, v46
  v_max_u32 v71, v71, v47
  v_cmp_eq_u32 s[4:5], -1, v64
  v_cmp_eq_u32 s[6:7], -1, v65
  v_cmp_eq_u32 s[8:9], -1, v66
  v_cmp_eq_u32 s[10:11], -1, v67
  v_cmp_eq_u32 s[12:13], -1, v68
  v_cmp_eq_u32 s[14:15], -1, v69
  v_cmp_eq_u32 s[16:17], -1, v70
  v_cmp_eq_u32 s[18:19], -1, v71
  s_or_b64 vcc, s[4:5], s[6:7]
  s_or_b64 vcc, vcc, s[8:9]
  s_or_b64 vcc, vcc, s[10:11]
  s_or_b64 vcc, vcc, s[12:13]
  s_or_b64 vcc, vcc, s[14:15]
  s_or_b64 vcc, vcc, s[16:17]
  s_or_b64 vcc, vcc, s[18:19]
  s_cbranch_scc0 Lq14_out
  s_sub_u32 s65, s65, 1
  s_cbranch_scc1 Lq14_out
Lq14_in:
  s_mov_b64 exec, s[4:5]
  buffer_load_dwordx4 v[16:19], v15, s[44:47], s74 offen sc1
  s_mov_b64 exec, s[6:7]
  buffer_load_dwordx4 v[20:23], v15, s[44:47], s29 offen sc1
  s_mov_b64 exec, s[8:9]
  buffer_load_dwordx4 v[24:27], v15, s[44:47], s30 offen sc1
  s_mov_b64 exec, s[10:11]
  buffer_load_dwordx4 v[28:31], v15, s[44:47], s31 offen sc1
  s_mov_b64 exec, s[12:13]
  buffer_load_dwordx4 v[32:35], v15, s[44:47], s32 offen sc1
  s_mov_b64 exec, s[14:15]
  buffer_load_dwordx4 v[36:39], v15, s[44:47], s33 offen sc1
  s_mov_b64 exec, s[16:17]
  buffer_load_dwordx4 v[40:43], v15, s[44:47], s34 offen sc1
  s_mov_b64 exec, s[18:19]
  buffer_load_dwordx4 v[44:47], v15, s[44:47], s35 offen sc1
  s_mov_b64 exec, -1
  s_waitcnt vmcnt(0)
  v_pk_add_f32 v[64:65], v[16:17], v[20:21]
  v_pk_add_f32 v[66:67], v[18:19], v[22:23]
  v_pk_add_f32 v[68:69], v[24:25], v[28:29]
  v_pk_add_f32 v[70:71], v[26:27], v[30:31]
  v_pk_add_f32 v[72:73], v[32:33], v[36:37]
  v_pk_add_f32 v[74:75], v[34:35], v[38:39]
  v_pk_add_f32 v[76:77], v[40:41], v[44:45]
  v_pk_add_f32 v[78:79], v[42:43], v[46:47]
  v_pk_add_f32 v[64:65], v[64:65], v[68:69]
  v_pk_add_f32 v[66:67], v[66:67], v[70:71]
  v_pk_add_f32 v[72:73], v[72:73], v[76:77]
  v_pk_add_f32 v[74:75], v[74:75], v[78:79]
  v_pk_add_f32 v[56:57], v[64:65], v[72:73]
  v_pk_add_f32 v[58:59], v[66:67], v[74:75]
  v_pk_add_f32 v[64:65], v[56:57], v[58:59]
  v_cmp_u_f32 vcc, v64, v65
  v_cvt_pk_bf16_f32 v56, 0, v56
  v_cvt_pk_bf16_f32 v57, 0, v57
  v_cvt_pk_bf16_f32 v58, 0, v58
  v_cvt_pk_bf16_f32 v59, 0, v59
  s_cbranch_vccnz Lq14
Lq14_out:
  v_pk_add_f32 v[56:57], v[56:57], v[48:49]
  v_pk_add_f32 v[58:59], v[58:59], v[50:51]
  v_cvt_pk_bf16_f32 v56, v56, v57
  v_cvt_pk_bf16_f32 v57, v58, v59
  ds_write_b64 v6, v[56:57] offset:47616
  s_waitcnt lgkmcnt(0)
L_p4t:
  s_barrier
  s_cmp_ge_u32 s60, 12
  s_cbranch_scc1 L_p4st
  ds_read_b128 v[16:19], v14 offset:47616
  ds_read_b128 v[20:23], v14 offset:48384
  ds_read_b32 v55, v61 offset:46080
  s_waitcnt lgkmcnt(1)
  v_mfma_f32_16x16x32_bf16 v[32:35], v[96:99], v[16:19], 0
  v_mfma_f32_16x16x32_bf16 v[36:39], v[100:103], v[16:19], 0
  v_mfma_f32_16x16x32_bf16 v[40:43], v[104:107], v[16:19], 0
  v_mfma_f32_16x16x32_bf16 v[44:47], v[108:111], v[16:19], 0
  s_cmp_ge_u32 s60, 8
  s_cbranch_scc1 L_p4b
  v_mfma_f32_16x16x32_bf16 v[32:35], v[112:115], v[20:23], v[32:35]
  v_mfma_f32_16x16x32_bf16 v[36:39], v[116:119], v[20:23], v[36:39]
  v_mfma_f32_16x16x32_bf16 v[40:43], v[120:123], v[20:23], v[40:43]
  v_mfma_f32_16x16x32_bf16 v[44:47], v[124:127], v[20:23], v[44:47]
L_p4b:
  s_nop 4
  s_nop 0
  v_mov_b32_dpp v32, v36 quad_perm:[0,1,2,3] row_mask:0xf bank_mask:0x2
  v_mov_b32_dpp v33, v37 quad_perm:[0,1,2,3] row_mask:0xf bank_mask:0x2
  v_mov_b32_dpp v34, v38 quad_perm:[0,1,2,3] row_mask:0xf bank_mask:0x2
  v_mov_b32_dpp v35, v39 quad_perm:[0,1,2,3] row_mask:0xf bank_mask:0x2
  v_mov_b32_dpp v32, v40 quad_perm:[0,1,2,3] row_mask:0xf bank_mask:0x4
  v_mov_b32_dpp v33, v41 quad_perm:[0,1,2,3] row_mask:0xf bank_mask:0x4
  v_mov_b32_dpp v34, v42 quad_perm:[0,1,2,3] row_mask:0xf bank_mask:0x4
  v_mov_b32_dpp v35, v43 quad_perm:[0,1,2,3] row_mask:0xf bank_mask:0x4
  v_mov_b32_dpp v32, v44 quad_perm:[0,1,2,3] row_mask:0xf bank_mask:0x8
  v_mov_b32_dpp v33, v45 quad_perm:[0,1,2,3] row_mask:0xf bank_mask:0x8
  v_mov_b32_dpp v34, v46 quad_perm:[0,1,2,3] row_mask:0xf bank_mask:0x8
  v_mov_b32_dpp v35, v47 quad_perm:[0,1,2,3] row_mask:0xf bank_mask:0x8
  ds_write_b128 v2, v[32:35] offset:10240
  s_waitcnt lgkmcnt(0)
L_p4bar2:
  s_barrier
  s_cmp_ge_u32 s60, 4
  s_cbranch_scc0 Lcont2
  s_endpgm
Lcont2:
  ds_read_b64 v[44:45], v9 offset:47104
  ds_read_b128 v[32:35], v12 offset:10240
  ds_read_b128 v[36:39], v12 offset:11520
  ds_read_b128 v[40:43], v12 offset:12800
  s_waitcnt lgkmcnt(3)
  v_max_f32 v45, 0, v45
  v_cvt_pk_bf16_f32 v45, 0, v45
  v_add_f32 v45, 0x3727c5ac, v45
  v_cvt_pk_bf16_f32 v45, 0, v45
  v_sqrt_f32 v45, v45
  v_cvt_pk_bf16_f32 v44, 0, v44
  s_waitcnt lgkmcnt(1)
  v_pk_add_f32 v[32:33], v[32:33], v[36:37]
  v_cvt_pk_bf16_f32 v45, 0, v45
  v_pk_add_f32 v[34:35], v[34:35], v[38:39]
  v_rcp_f32 v45, v45
  s_waitcnt lgkmcnt(0)
  v_pk_add_f32 v[32:33], v[32:33], v[40:41]
  v_pk_add_f32 v[34:35], v[34:35], v[42:43]
  s_nop 1
  v_permlane32_swap_b32 v32, v34
  v_permlane32_swap_b32 v33, v35
  v_pk_add_f32 v[32:33], v[32:33], v[34:35]
  s_nop 1
  v_permlane16_swap_b32 v32, v33
  v_add_f32 v32, v32, v33
  v_fma_f32 v16, -v44, v55, v32
  v_mul_f32 v16, v16, v45
  s_cmp_eq_u32 s58, 1
  s_cbranch_scc1 L_p4c
  v_cvt_pk_bf16_f32 v16, 0, v16
  v_mul_f32 v17, 0xbfb8aa3b, v16
  v_exp_f32 v17, v17
  s_nop 0
  v_add_f32 v17, 1.0, v17
  v_rcp_f32 v17, v17
  s_nop 0
  v_mul_f32 v16, v16, v17
L_p4c:
  s_nop 1
  v_mov_b32_dpp v17, v16 quad_perm:[0,0,2,2] row_mask:0xf bank_mask:0xf
  v_mov_b32_dpp v18, v16 quad_perm:[1,1,3,3] row_mask:0xf bank_mask:0xf
  v_cvt_pk_bf16_f32 v16, v17, v18
  v_min_u32 v16, -2, v16
  buffer_store_dword v16, v10, s[44:47], s70 offen sc1
  s_endpgm
L_p4cs:
  s_cmp_lg_u32 s60, 15
  s_cbranch_scc1 L_gate4
  v_and_b32 v7, 63, v0
  v_lshlrev_b32 v7, 11, v7
  s_and_b32 s78, s64, 3
  s_lshl_b32 s78, s78, 9
  s_mov_b32 s65, 100000
  s_branch Lpoll15_in
Lpoll15:
  s_mov_b64 exec, vcc
  s_sleep 4
  s_sub_u32 s65, s65, 1
  s_cbranch_scc1 Lpoll15_out
Lpoll15_in:
  buffer_load_dword v5, v7, s[44:47], s78 offen sc1
  s_waitcnt vmcnt(0)
Lpoll15_ck:
  v_cmp_eq_u32 vcc, -1, v5
  s_nop 0
  s_bcnt1_i32_b64 s61, vcc
  s_cmp_le_u32 s61, 8
  s_cselect_b64 vcc, 0, vcc
  s_cbranch_vccnz Lpoll15
Lpoll15_out:
  s_mov_b64 exec, -1
  s_mov_b32 s65, 400000
  s_branch Lpoll16_in
Lpoll16:
  s_sleep 1
  s_sub_u32 s65, s65, 1
  s_cbranch_scc1 Lpoll16_out
Lpoll16_in:
  ds_read_b32 v60, v62 offset:548
  s_waitcnt lgkmcnt(0)
Lpoll16_ck:
  v_cmp_ne_u32 vcc, 12, v60
  s_cbranch_vccnz Lpoll16
Lpoll16_out:
  ds_write_b32 v62, v63 offset:544
L_gate4:
  s_mov_b32 s65, 266666
  s_branch Lpoll17_in
Lpoll17:
  s_sleep 2
  s_sub_u32 s65, s65, 1
  s_cbranch_scc1 Lpoll17_out
Lpoll17_in:
  ds_read_b32 v60, v62 offset:540
  s_waitcnt lgkmcnt(0)
Lpoll17_ck:
  v_cmp_ne_u32 vcc, 12, v60
  s_cbranch_vccnz Lpoll17
Lpoll17_out:
  ds_read_b128 v[32:35], v12 offset:29952
  ds_read_b128 v[36:39], v12 offset:31232
  ds_read_b128 v[40:43], v12 offset:32512
  s_waitcnt lgkmcnt(0)
  v_pk_add_f32 v[32:33], v[32:33], v[36:37]
  v_pk_add_f32 v[34:35], v[34:35], v[38:39]
  v_pk_add_f32 v[32:33], v[32:33], v[40:41]
  v_pk_add_f32 v[34:35], v[34:35], v[42:43]
  s_nop 1
  v_permlane32_swap_b32 v32, v34
  v_permlane32_swap_b32 v33, v35
  v_pk_add_f32 v[32:33], v[32:33], v[34:35]
  s_nop 1
  v_permlane16_swap_b32 v32, v33
  v_add_f32 v32, v32, v33
  ds_write_b32 v61, v32 offset:46080
  s_waitcnt lgkmcnt(0)
  s_mov_b32 s77, 0
  s_setprio 3
  s_branch L_p4t
L_p4st:
  ds_read_b32 v16, v8 offset:47616
  ds_read_b32 v17, v8 offset:47872
  ds_read_b32 v18, v8 offset:48128
  ds_read_b32 v19, v8 offset:48384
  ds_read_b32 v20, v8 offset:48640
  s_waitcnt lgkmcnt(0)
  v_lshlrev_b32 v24, 16, v16
  v_and_b32 v25, 0xffff0000, v16
  v_lshlrev_b32 v26, 16, v17
  v_and_b32 v27, 0xffff0000, v17
  v_lshlrev_b32 v28, 16, v18
  v_and_b32 v29, 0xffff0000, v18
  v_lshlrev_b32 v30, 16, v19
  v_and_b32 v31, 0xffff0000, v19
  v_lshlrev_b32 v32, 16, v20
  v_and_b32 v33, 0xffff0000, v20
  v_readfirstlane_b32 s75, v24
  s_nop 1
  v_sub_f32 v22, 0, s75
  v_mov_b32 v23, v22
  v_pk_add_f32 v[24:25], v[24:25], v[22:23]
  v_pk_add_f32 v[26:27], v[26:27], v[22:23]
  v_pk_add_f32 v[28:29], v[28:29], v[22:23]
  v_pk_add_f32 v[30:31], v[30:31], v[22:23]
  v_pk_add_f32 v[32:33], v[32:33], v[22:23]
  v_pk_mul_f32 v[36:37], v[24:25], v[24:25]
  v_pk_add_f32 v[34:35], v[24:25], v[26:27]
  v_pk_fma_f32 v[36:37], v[26:27], v[26:27], v[36:37]
  v_pk_add_f32 v[34:35], v[34:35], v[28:29]
  v_pk_fma_f32 v[36:37], v[28:29], v[28:29], v[36:37]
  v_pk_add_f32 v[34:35], v[34:35], v[30:31]
  v_pk_fma_f32 v[36:37], v[30:31], v[30:31], v[36:37]
  v_pk_add_f32 v[34:35], v[34:35], v[32:33]
  v_pk_fma_f32 v[36:37], v[32:33], v[32:33], v[36:37]
  v_add_f32 v34, v34, v35
  v_add_f32 v35, v36, v37
  s_nop 0
  v_add_f32_dpp v34, v34, v34 quad_perm:[1,0,3,2] row_mask:0xf bank_mask:0xf
  v_add_f32_dpp v35, v35, v35 quad_perm:[1,0,3,2] row_mask:0xf bank_mask:0xf
  s_nop 0
  v_add_f32_dpp v34, v34, v34 quad_perm:[2,3,0,1] row_mask:0xf bank_mask:0xf
  v_add_f32_dpp v35, v35, v35 quad_perm:[2,3,0,1] row_mask:0xf bank_mask:0xf
  s_nop 0
  v_add_f32_dpp v34, v34, v34 row_half_mirror row_mask:0xf bank_mask:0xf
  v_add_f32_dpp v35, v35, v35 row_half_mirror row_mask:0xf bank_mask:0xf
  s_nop 0
  v_add_f32_dpp v34, v34, v34 row_mirror row_mask:0xf bank_mask:0xf
  v_add_f32_dpp v35, v35, v35 row_mirror row_mask:0xf bank_mask:0xf
  s_nop 0
  v_add_f32_dpp v34, v34, v34 row_bcast:15 row_mask:0xa bank_mask:0xf
  v_add_f32_dpp v35, v35, v35 row_bcast:15 row_mask:0xa bank_mask:0xf
  s_nop 0
  v_add_f32_dpp v34, v34, v34 row_bcast:31 row_mask:0xc bank_mask:0xf
  v_add_f32_dpp v35, v35, v35 row_bcast:31 row_mask:0xc bank_mask:0xf
  v_mul_f32 v34, 0x3acccccd, v34
  v_mul_f32 v35, 0x3acccccd, v35
  v_fma_f32 v35, -v34, v34, v35
  v_add_f32 v34, s75, v34
  s_mov_b32 exec_lo, 0
  s_mov_b32 exec_hi, 0x80000000
  ds_write_b64 v54, v[34:35] offset:47104
  s_mov_b64 exec, -1
  s_waitcnt lgkmcnt(0)
  s_branch L_p4bar2
L_fin:
L_end:
  s_endpgm
.section .rodata,"a"
.p2align 6
.amdhsa_kernel sequential_preLN__sliding_block_cached__glu_gated_swiglu__decode_kernel
  .amdhsa_next_free_vgpr 128
  .amdhsa_next_free_sgpr 102
  .amdhsa_accum_offset 128
  .amdhsa_group_segment_fixed_size 0
  .amdhsa_kernarg_size 96
  .amdhsa_user_sgpr_count 2
  .amdhsa_user_sgpr_kernarg_segment_ptr 1
  .amdhsa_system_sgpr_workgroup_id_x 1
  .amdhsa_float_denorm_mode_32 3
.end_amdhsa_kernel
```
